```python
import torch

def _softmax(x, axis=-1):
    return torch.softmax(x, dim=axis)
def _gelu(x):
    return torch.nn.functional.gelu(x, approximate="tanh")
def _silu(x):
    return torch.nn.functional.silu(x)
def _sigmoid(x):
    return torch.sigmoid(x)
def _layernorm(x, axis=-1, eps=1e-5):
    m = x.mean(dim=axis, keepdim=True)
    v = x.var(dim=axis, keepdim=True, unbiased=False)
    return (x - m) / torch.sqrt(v + eps)
def _scatter_add(tgt, idx, src, axis=0):
    return tgt.clone().index_add_(axis, idx, src)
def _segment_sum(src, seg, n):
    out = torch.zeros((n,) + src.shape[1:], dtype=src.dtype)
    return out.index_add_(0, seg, src)
def _pad(x, pw):
    flat = tuple(v for pair in reversed(pw) for v in pair)
    return torch.nn.functional.pad(x, flat)

kernel_name = 'recurrent_scan__grouped_kv_mqa__geglu_ffn__prompt'

def setup_inputs():

    _w = (lambda a: (lambda t: t.to(torch.bfloat16) if t.is_floating_point() else t)(torch.as_tensor(a)))
    def _A_setup():
        B, S, D, H = 1, 2048, 512, 32
        Dh = D // H
        return {
            "x": _w((lambda *s: torch.randn(*s, dtype=torch.bfloat16) * 0.05)(B, S, D)),
            "wq": _w((lambda *s: torch.randn(*s, dtype=torch.bfloat16) * 0.05)(D, H * Dh)),
            "wk": _w((lambda *s: torch.randn(*s, dtype=torch.bfloat16) * 0.05)(D, Dh)),
            "wv": _w((lambda *s: torch.randn(*s, dtype=torch.bfloat16) * 0.05)(D, Dh)),
            "wo": _w((lambda *s: torch.randn(*s, dtype=torch.bfloat16) * 0.05)(H * Dh, D)),
        }
    _A_in = _A_setup()

    def _B_setup():
        B, S, D, F = 1, 2048, 512, 1792
        return {
            "x": _w((lambda *s: torch.randn(*s, dtype=torch.bfloat16) * 0.05)(B, S, D)),
            "w_gate": _w((lambda *s: torch.randn(*s, dtype=torch.bfloat16) * 0.05)(D, F)),
            "w_up": _w((lambda *s: torch.randn(*s, dtype=torch.bfloat16) * 0.05)(D, F)),
            "w_down": _w((lambda *s: torch.randn(*s, dtype=torch.bfloat16) * 0.05)(F, D)),
        }
    _B_in = _B_setup()

    return {
        "A_x": _A_in["x"],
        "A_wq": _A_in["wq"],
        "A_wk": _A_in["wk"],
        "A_wv": _A_in["wv"],
        "A_wo": _A_in["wo"],
        "B_x": _B_in["x"],
        "B_w_gate": _B_in["w_gate"],
        "B_w_up": _B_in["w_up"],
        "B_w_down": _B_in["w_down"],
    }

def reference(A_x, A_wq, A_wk, A_wv, A_wo, B_x, B_w_gate, B_w_up, B_w_down):
    def _A_ref(x, wq, wk, wv, wo):
        B, S, D = x.shape
        H = 32
        Dh = D // H
        q = (lambda x, *d: x.permute(*d))((x @ wq).reshape(B, S, H, Dh), 0, 2, 1, 3)
        k = x @ wk
        v = x @ wv
        scores = torch.einsum("bhqd,bkd->bhqk", q, k) * (Dh ** -0.5)
        p = _softmax(scores, axis=-1)
        o = torch.einsum("bhqk,bkd->bhqd", p, v)
        return (lambda x, *d: x.permute(*d))(o, 0, 2, 1, 3).reshape(B, S, H * Dh) @ wo

    def _B_ref(x, w_gate, w_up, w_down):
        return (_gelu(x @ w_gate) * (x @ w_up)) @ w_down

    x = A_x
    xn = _layernorm(x, axis=-1)
    s = _A_ref(xn, A_wq, A_wk, A_wv, A_wo)
    g = _silu(_B_ref(xn, B_w_gate, B_w_up, B_w_down))
    return x + s * g
```

```asm
; @launch grid=(512,1,1) block=(256,1,1) lds=81920
.amdgcn_target "amdgcn-amd-amdhsa--gfx950"
.text
.globl recurrent_scan__grouped_kv_mqa__geglu_ffn__prompt_kernel
.p2align 8
.type recurrent_scan__grouped_kv_mqa__geglu_ffn__prompt_kernel,@function
recurrent_scan__grouped_kv_mqa__geglu_ffn__prompt_kernel:
  s_cmp_ge_u32 s2, 512
  s_cbranch_scc1 .Lrecurr_end1
  s_and_b32 s3, s2, 255
  s_cmp_ge_u32 s2, 256
  s_cbranch_scc1 .Lrecurr_roleg2
  s_setprio 3
  s_load_dwordx4 s[4:7], s[0:1], 0
  s_load_dwordx4 s[8:11], s[0:1], 16
  s_load_dwordx2 s[12:13], s[0:1], 88
  s_load_dwordx2 s[50:51], s[0:1], 64
  s_load_dwordx2 s[52:53], s[0:1], 32
  s_and_b32 s14, s3, 7
  s_lshl_b32 s14, s14, 2
  s_lshr_b32 s15, s3, 6
  s_add_u32 s14, s14, s15
  s_bfe_u32 s15, s3, 0x30003
  s_lshl_b32 s33, s14, 2
  s_and_b32 s18, s15, 3
  s_add_u32 s33, s33, s18
  v_lshrrev_b32 v1, 6, v0
  v_and_b32 v2, 63, v0
  v_readfirstlane_b32 s16, v1
  v_lshrrev_b32 v6, 4, v2
  v_and_b32 v7, 15, v2
  v_lshlrev_b32 v5, 10, v6
  v_lshl_add_u32 v5, v7, 4, v5
  v_lshlrev_b32 v12, 4, v2
  s_lshl_b32 s17, s33, 14
  s_lshl_b32 s18, s16, 12
  s_add_u32 s17, s17, s18
  s_lshl_b32 s19, s16, 12
  s_lshl_b32 s37, s16, 14
  s_add_u32 s37, s37, 16384
  v_lshrrev_b32 v8, 3, v2
  v_and_b32 v9, 7, v2
  v_lshlrev_b32 v10, 1, v8
  v_and_b32 v10, 4, v10
  v_xor_b32 v10, v10, v9
  v_lshlrev_b32 v10, 4, v10
  v_lshl_add_u32 v120, v8, 10, v10
  v_add_u32 v121, 7168, v120
  v_add_u32 v122, 14336, v120
  v_add_u32 v123, 21504, v120
  s_lshl_b32 s34, s16, 17
  s_lshl_b32 s35, s15, 7
  s_add_u32 s34, s34, s35
  s_cmp_ge_u32 s15, 4
  s_waitcnt lgkmcnt(0)
  s_cselect_b32 s28, s10, s8
  s_cselect_b32 s29, s11, s9
  s_mov_b32 s44, s4
  s_mov_b32 s45, s5
  s_mov_b32 s46, 0x200000
  s_mov_b32 s47, 0x20000
  buffer_load_dwordx4 v[16:19], v5, s[44:47], s17 offen offset:0
  buffer_load_dwordx4 v[20:23], v5, s[44:47], s17 offen offset:256
  buffer_load_dwordx4 v[24:27], v5, s[44:47], s17 offen offset:512
  buffer_load_dwordx4 v[28:31], v5, s[44:47], s17 offen offset:768
  s_mov_b32 s30, 16384
  s_mov_b32 s31, 0x20000
  s_mov_b32 m0, s19
  s_mov_b32 s20, s12
  s_mov_b32 s21, s13
  s_mov_b32 s22, 0x1000000
  s_mov_b32 s23, 0x20000
  buffer_load_dwordx4 v12, s[28:31], s19 offen offset:0 lds
  buffer_load_dwordx4 v12, s[28:31], s19 offen offset:1024 lds
  buffer_load_dwordx4 v12, s[28:31], s19 offen offset:2048 lds
  buffer_load_dwordx4 v12, s[28:31], s19 offen offset:3072 lds
  v_mov_b32 v100, 0
  s_mov_b32 s56, 0xe60000
  buffer_load_dwordx2 v[98:99], v100, s[20:23], s56 offen
  s_mov_b32 s4, s6
  s_mov_b32 s5, s7
  s_mov_b32 s6, 524288
  s_mov_b32 s7, 0x20000
  s_cmp_lg_u32 s16, 3
  s_cbranch_scc1 .Lrecurr_nt3
  v_lshlrev_b32 v10, 7, v7
  s_lshl_b32 s38, s3, 11
  buffer_load_dword v11, v10, s[4:7], s38 offen
.Lrecurr_nt3:
  v_lshrrev_b32 v3, 5, v2
  v_and_b32 v4, 31, v2
  v_add_u32 v10, 0, v6
  v_xor_b32 v11, v10, v7
  v_lshlrev_b32 v11, 4, v11
  v_lshl_add_u32 v112, v10, 10, v11
  v_add_u32 v10, 4, v6
  v_xor_b32 v11, v10, v7
  v_lshlrev_b32 v11, 4, v11
  v_lshl_add_u32 v113, v10, 10, v11
  v_subrev_u32 v113, 1024, v113
  v_add_u32 v10, 8, v6
  v_xor_b32 v11, v10, v7
  v_lshlrev_b32 v11, 4, v11
  v_lshl_add_u32 v114, v10, 10, v11
  v_subrev_u32 v114, 2048, v114
  v_add_u32 v10, 12, v6
  v_xor_b32 v11, v10, v7
  v_lshlrev_b32 v11, 4, v11
  v_lshl_add_u32 v115, v10, 10, v11
  v_subrev_u32 v115, 3072, v115
  s_lshl_b32 s35, s14, 16
  s_lshl_b32 s38, s16, 8
  s_add_u32 s35, s35, s38
  v_bfe_u32 v9, v2, 2, 2
  v_lshl_add_u32 v8, v3, 3, v9
  v_lshlrev_b32 v8, 7, v8
  v_and_b32 v10, 1, v2
  v_lshl_add_u32 v8, v10, 3, v8
  v_add_u32 v8, s37, v8
  v_bfe_u32 v10, v2, 4, 1
  v_bfe_u32 v11, v2, 1, 1
  v_lshl_add_u32 v10, v10, 1, v11
  v_lshlrev_b32 v11, 1, v9
  v_and_b32 v11, 4, v11
  v_xor_b32 v10, v10, v11
  v_lshl_add_u32 v125, v10, 4, v8
  v_xor_b32 v10, 4, v10
  v_lshl_add_u32 v126, v10, 4, v8
  v_xor_b32 v10, v7, v3
  v_lshlrev_b32 v10, 4, v10
  v_lshl_add_u32 v124, v4, 8, v10
  v_add_u32 v124, s37, v124
  v_lshl_add_u32 v10, v6, 3, v9
  v_and_b32 v11, 3, v2
  v_lshlrev_b32 v11, 3, v11
  v_lshl_add_u32 v118, v10, 5, v11
  s_lshl_b32 s38, s16, 2
  v_add_u32 v10, s38, v6
  v_xor_b32 v11, v10, v7
  v_lshlrev_b32 v11, 4, v11
  v_lshl_add_u32 v117, v10, 10, v11
  v_add_u32 v10, 0, v6
  v_xor_b32 v10, v10, v7
  v_lshlrev_b32 v10, 4, v10
  v_lshl_add_u32 v108, v7, 10, v10
  v_add_u32 v10, 4, v6
  v_xor_b32 v10, v10, v7
  v_lshlrev_b32 v10, 4, v10
  v_lshl_add_u32 v109, v7, 10, v10
  v_add_u32 v10, 8, v6
  v_xor_b32 v10, v10, v7
  v_lshlrev_b32 v10, 4, v10
  v_lshl_add_u32 v110, v7, 10, v10
  v_add_u32 v10, 12, v6
  v_xor_b32 v10, v10, v7
  v_lshlrev_b32 v10, 4, v10
  v_lshl_add_u32 v111, v7, 10, v10
  s_mov_b32 s36, 0xffff0000
  s_waitcnt vmcnt(5)
  v_lshlrev_b32 v48, 16, v16
  v_and_b32 v49, s36, v16
  v_lshlrev_b32 v50, 16, v17
  v_and_b32 v51, s36, v17
  v_lshlrev_b32 v52, 16, v18
  v_and_b32 v53, s36, v18
  v_lshlrev_b32 v54, 16, v19
  v_and_b32 v55, s36, v19
  v_lshlrev_b32 v56, 16, v20
  v_and_b32 v57, s36, v20
  v_lshlrev_b32 v58, 16, v21
  v_and_b32 v59, s36, v21
  v_lshlrev_b32 v60, 16, v22
  v_and_b32 v61, s36, v22
  v_lshlrev_b32 v62, 16, v23
  v_and_b32 v63, s36, v23
  v_lshlrev_b32 v64, 16, v24
  v_and_b32 v65, s36, v24
  v_lshlrev_b32 v66, 16, v25
  v_and_b32 v67, s36, v25
  v_lshlrev_b32 v68, 16, v26
  v_and_b32 v69, s36, v26
  v_lshlrev_b32 v70, 16, v27
  v_and_b32 v71, s36, v27
  v_lshlrev_b32 v72, 16, v28
  v_and_b32 v73, s36, v28
  v_lshlrev_b32 v74, 16, v29
  v_and_b32 v75, s36, v29
  v_lshlrev_b32 v76, 16, v30
  v_and_b32 v77, s36, v30
  v_lshlrev_b32 v78, 16, v31
  v_and_b32 v79, s36, v31
  v_pk_add_f32 v[80:81], v[48:49], v[56:57]
  v_pk_add_f32 v[82:83], v[50:51], v[58:59]
  v_pk_add_f32 v[84:85], v[52:53], v[60:61]
  v_pk_add_f32 v[86:87], v[54:55], v[62:63]
  v_pk_add_f32 v[80:81], v[80:81], v[64:65]
  v_pk_add_f32 v[82:83], v[82:83], v[66:67]
  v_pk_add_f32 v[84:85], v[84:85], v[68:69]
  v_pk_add_f32 v[86:87], v[86:87], v[70:71]
  v_pk_add_f32 v[80:81], v[80:81], v[72:73]
  v_pk_add_f32 v[82:83], v[82:83], v[74:75]
  v_pk_add_f32 v[84:85], v[84:85], v[76:77]
  v_pk_add_f32 v[86:87], v[86:87], v[78:79]
  v_pk_add_f32 v[80:81], v[80:81], v[82:83]
  v_pk_add_f32 v[84:85], v[84:85], v[86:87]
  v_pk_add_f32 v[80:81], v[80:81], v[84:85]
  v_add_f32 v80, v80, v81
  s_nop 1
  v_add_f32_dpp v80, v80, v80 quad_perm:[1,0,3,2] row_mask:0xf bank_mask:0xf
  s_nop 1
  v_add_f32_dpp v80, v80, v80 quad_perm:[2,3,0,1] row_mask:0xf bank_mask:0xf
  s_nop 1
  v_add_f32_dpp v80, v80, v80 row_half_mirror row_mask:0xf bank_mask:0xf
  s_nop 1
  v_add_f32_dpp v80, v80, v80 row_mirror row_mask:0xf bank_mask:0xf
  s_waitcnt vmcnt(1)
  s_barrier
  s_cmp_lg_u32 s16, 0
  s_cbranch_scc1 .Lrecurr_nw4
  ds_read_b64_tr_b16 v[128:129], v118 offset:0
  ds_read_b64_tr_b16 v[130:131], v118 offset:128
  ds_read_b64_tr_b16 v[132:133], v118 offset:1024
  ds_read_b64_tr_b16 v[134:135], v118 offset:1152
  ds_read_b64_tr_b16 v[136:137], v118 offset:2048
  ds_read_b64_tr_b16 v[138:139], v118 offset:2176
  ds_read_b64_tr_b16 v[140:141], v118 offset:3072
  ds_read_b64_tr_b16 v[142:143], v118 offset:3200
  ds_read_b64_tr_b16 v[144:145], v118 offset:4096
  ds_read_b64_tr_b16 v[146:147], v118 offset:4224
  ds_read_b64_tr_b16 v[148:149], v118 offset:5120
  ds_read_b64_tr_b16 v[150:151], v118 offset:5248
  ds_read_b64_tr_b16 v[152:153], v118 offset:6144
  ds_read_b64_tr_b16 v[154:155], v118 offset:6272
  ds_read_b64_tr_b16 v[156:157], v118 offset:7168
  ds_read_b64_tr_b16 v[158:159], v118 offset:7296
  ds_read_b64_tr_b16 v[160:161], v118 offset:8192
  ds_read_b64_tr_b16 v[162:163], v118 offset:8320
  ds_read_b64_tr_b16 v[164:165], v118 offset:9216
  ds_read_b64_tr_b16 v[166:167], v118 offset:9344
  ds_read_b64_tr_b16 v[168:169], v118 offset:10240
  ds_read_b64_tr_b16 v[170:171], v118 offset:10368
  ds_read_b64_tr_b16 v[172:173], v118 offset:11264
  ds_read_b64_tr_b16 v[174:175], v118 offset:11392
  ds_read_b64_tr_b16 v[176:177], v118 offset:12288
  ds_read_b64_tr_b16 v[178:179], v118 offset:12416
  ds_read_b64_tr_b16 v[180:181], v118 offset:13312
  ds_read_b64_tr_b16 v[182:183], v118 offset:13440
  ds_read_b64_tr_b16 v[184:185], v118 offset:14336
  ds_read_b64_tr_b16 v[186:187], v118 offset:14464
  ds_read_b64_tr_b16 v[188:189], v118 offset:15360
  ds_read_b64_tr_b16 v[190:191], v118 offset:15488
.Lrecurr_nw4:
  v_mul_f32 v88, 0xbb000000, v80
  v_cvt_pk_bf16_f32 v90, v88, v88
  v_and_b32 v90, s36, v90
  v_mov_b32 v91, v90
  v_sub_f32 v89, v90, v88
  v_pk_add_f32 v[48:49], v[48:49], v[90:91]
  v_pk_add_f32 v[50:51], v[50:51], v[90:91]
  v_pk_add_f32 v[52:53], v[52:53], v[90:91]
  v_pk_add_f32 v[54:55], v[54:55], v[90:91]
  v_pk_add_f32 v[56:57], v[56:57], v[90:91]
  v_pk_add_f32 v[58:59], v[58:59], v[90:91]
  v_pk_add_f32 v[60:61], v[60:61], v[90:91]
  v_pk_add_f32 v[62:63], v[62:63], v[90:91]
  v_pk_add_f32 v[64:65], v[64:65], v[90:91]
  v_pk_add_f32 v[66:67], v[66:67], v[90:91]
  v_pk_add_f32 v[68:69], v[68:69], v[90:91]
  v_pk_add_f32 v[70:71], v[70:71], v[90:91]
  v_pk_add_f32 v[72:73], v[72:73], v[90:91]
  v_pk_add_f32 v[74:75], v[74:75], v[90:91]
  v_pk_add_f32 v[76:77], v[76:77], v[90:91]
  v_pk_add_f32 v[78:79], v[78:79], v[90:91]
  v_pk_mul_f32 v[80:81], v[48:49], v[48:49]
  v_pk_mul_f32 v[82:83], v[50:51], v[50:51]
  v_pk_mul_f32 v[84:85], v[52:53], v[52:53]
  v_pk_mul_f32 v[86:87], v[54:55], v[54:55]
  v_pk_fma_f32 v[80:81], v[56:57], v[56:57], v[80:81]
  v_pk_fma_f32 v[82:83], v[58:59], v[58:59], v[82:83]
  v_pk_fma_f32 v[84:85], v[60:61], v[60:61], v[84:85]
  v_pk_fma_f32 v[86:87], v[62:63], v[62:63], v[86:87]
  v_pk_fma_f32 v[80:81], v[64:65], v[64:65], v[80:81]
  v_pk_fma_f32 v[82:83], v[66:67], v[66:67], v[82:83]
  v_pk_fma_f32 v[84:85], v[68:69], v[68:69], v[84:85]
  v_pk_fma_f32 v[86:87], v[70:71], v[70:71], v[86:87]
  v_pk_fma_f32 v[80:81], v[72:73], v[72:73], v[80:81]
  v_pk_fma_f32 v[82:83], v[74:75], v[74:75], v[82:83]
  v_pk_fma_f32 v[84:85], v[76:77], v[76:77], v[84:85]
  v_pk_fma_f32 v[86:87], v[78:79], v[78:79], v[86:87]
  v_mul_f32 v89, v89, v89
  s_mov_b32 s38, 0x3b000000
  v_pk_add_f32 v[80:81], v[80:81], v[82:83]
  v_pk_add_f32 v[84:85], v[84:85], v[86:87]
  v_pk_add_f32 v[80:81], v[80:81], v[84:85]
  v_add_f32 v80, v80, v81
  s_nop 1
  v_add_f32_dpp v80, v80, v80 quad_perm:[1,0,3,2] row_mask:0xf bank_mask:0xf
  s_nop 1
  v_add_f32_dpp v80, v80, v80 quad_perm:[2,3,0,1] row_mask:0xf bank_mask:0xf
  s_nop 1
  v_add_f32_dpp v80, v80, v80 row_half_mirror row_mask:0xf bank_mask:0xf
  s_nop 1
  v_add_f32_dpp v80, v80, v80 row_mirror row_mask:0xf bank_mask:0xf
  v_fma_f32 v80, v80, s38, -v89
  v_max_f32 v80, 0, v80
  v_cvt_pk_bf16_f32 v80, v80, v80
  v_lshlrev_b32 v80, 16, v80
  v_add_f32 v80, 0x3727c5ac, v80
  v_cvt_pk_bf16_f32 v80, v80, v80
  v_lshlrev_b32 v80, 16, v80
  v_sqrt_f32 v80, v80
  s_waitcnt lgkmcnt(0)
  v_cvt_pk_bf16_f32 v80, v80, v80
  v_lshlrev_b32 v93, 16, v80
  v_rcp_f32 v88, v93
  s_barrier
  v_mov_b32 v89, v88
  v_cvt_pk_bf16_f32 v16, v48, v49
  v_cvt_pk_bf16_f32 v17, v50, v51
  v_cvt_pk_bf16_f32 v18, v52, v53
  v_cvt_pk_bf16_f32 v19, v54, v55
  v_lshlrev_b32 v48, 16, v16
  v_and_b32 v49, s36, v16
  v_lshlrev_b32 v50, 16, v17
  v_and_b32 v51, s36, v17
  v_lshlrev_b32 v52, 16, v18
  v_and_b32 v53, s36, v18
  v_lshlrev_b32 v54, 16, v19
  v_and_b32 v55, s36, v19
  v_pk_mul_f32 v[48:49], v[48:49], v[88:89]
  v_pk_mul_f32 v[50:51], v[50:51], v[88:89]
  v_pk_mul_f32 v[52:53], v[52:53], v[88:89]
  v_pk_mul_f32 v[54:55], v[54:55], v[88:89]
  v_cvt_pk_bf16_f32 v16, v48, v49
  v_cvt_pk_bf16_f32 v17, v50, v51
  v_cvt_pk_bf16_f32 v18, v52, v53
  v_cvt_pk_bf16_f32 v19, v54, v55
  ds_write_b128 v117, v[16:19] offset:0
  v_cvt_pk_bf16_f32 v20, v56, v57
  v_cvt_pk_bf16_f32 v21, v58, v59
  v_cvt_pk_bf16_f32 v22, v60, v61
  v_cvt_pk_bf16_f32 v23, v62, v63
  v_lshlrev_b32 v56, 16, v20
  v_and_b32 v57, s36, v20
  v_lshlrev_b32 v58, 16, v21
  v_and_b32 v59, s36, v21
  v_lshlrev_b32 v60, 16, v22
  v_and_b32 v61, s36, v22
  v_lshlrev_b32 v62, 16, v23
  v_and_b32 v63, s36, v23
  v_pk_mul_f32 v[56:57], v[56:57], v[88:89]
  v_pk_mul_f32 v[58:59], v[58:59], v[88:89]
  v_pk_mul_f32 v[60:61], v[60:61], v[88:89]
  v_pk_mul_f32 v[62:63], v[62:63], v[88:89]
  v_cvt_pk_bf16_f32 v20, v56, v57
  v_cvt_pk_bf16_f32 v21, v58, v59
  v_cvt_pk_bf16_f32 v22, v60, v61
  v_cvt_pk_bf16_f32 v23, v62, v63
  ds_write_b128 v117, v[20:23] offset:256
  v_cvt_pk_bf16_f32 v24, v64, v65
  v_cvt_pk_bf16_f32 v25, v66, v67
  v_cvt_pk_bf16_f32 v26, v68, v69
  v_cvt_pk_bf16_f32 v27, v70, v71
  v_lshlrev_b32 v64, 16, v24
  v_and_b32 v65, s36, v24
  v_lshlrev_b32 v66, 16, v25
  v_and_b32 v67, s36, v25
  v_lshlrev_b32 v68, 16, v26
  v_and_b32 v69, s36, v26
  v_lshlrev_b32 v70, 16, v27
  v_and_b32 v71, s36, v27
  v_pk_mul_f32 v[64:65], v[64:65], v[88:89]
  v_pk_mul_f32 v[66:67], v[66:67], v[88:89]
  v_pk_mul_f32 v[68:69], v[68:69], v[88:89]
  v_pk_mul_f32 v[70:71], v[70:71], v[88:89]
  v_cvt_pk_bf16_f32 v24, v64, v65
  v_cvt_pk_bf16_f32 v25, v66, v67
  v_cvt_pk_bf16_f32 v26, v68, v69
  v_cvt_pk_bf16_f32 v27, v70, v71
  ds_write_b128 v117, v[24:27] offset:512
  v_cvt_pk_bf16_f32 v28, v72, v73
  v_cvt_pk_bf16_f32 v29, v74, v75
  v_cvt_pk_bf16_f32 v30, v76, v77
  v_cvt_pk_bf16_f32 v31, v78, v79
  v_lshlrev_b32 v72, 16, v28
  v_and_b32 v73, s36, v28
  v_lshlrev_b32 v74, 16, v29
  v_and_b32 v75, s36, v29
  v_lshlrev_b32 v76, 16, v30
  v_and_b32 v77, s36, v30
  v_lshlrev_b32 v78, 16, v31
  v_and_b32 v79, s36, v31
  v_pk_mul_f32 v[72:73], v[72:73], v[88:89]
  v_pk_mul_f32 v[74:75], v[74:75], v[88:89]
  v_pk_mul_f32 v[76:77], v[76:77], v[88:89]
  v_pk_mul_f32 v[78:79], v[78:79], v[88:89]
  v_cvt_pk_bf16_f32 v28, v72, v73
  v_cvt_pk_bf16_f32 v29, v74, v75
  v_cvt_pk_bf16_f32 v30, v76, v77
  v_cvt_pk_bf16_f32 v31, v78, v79
  ds_write_b128 v117, v[28:31] offset:768
  s_waitcnt vmcnt(0) lgkmcnt(0)
  s_barrier
  s_cmp_lg_u32 s16, 0
  s_cbranch_scc1 .Lrecurr_q16
  ds_read_b128 v[192:195], v108 offset:0
  ds_read_b128 v[196:199], v109 offset:0
  ds_read_b128 v[200:203], v110 offset:0
  ds_read_b128 v[204:207], v111 offset:0
  ds_read_b128 v[208:211], v108 offset:256
  ds_read_b128 v[212:215], v109 offset:256
  ds_read_b128 v[216:219], v110 offset:256
  ds_read_b128 v[220:223], v111 offset:256
  ds_read_b128 v[224:227], v108 offset:512
  ds_read_b128 v[228:231], v109 offset:512
  ds_read_b128 v[232:235], v110 offset:512
  ds_read_b128 v[236:239], v111 offset:512
  ds_read_b128 v[240:243], v108 offset:768
  ds_read_b128 v[244:247], v109 offset:768
  ds_read_b128 v[248:251], v110 offset:768
  ds_read_b128 v[252:255], v111 offset:768
  s_waitcnt vmcnt(0)
  v_readfirstlane_b32 s56, v98
  v_readfirstlane_b32 s57, v99
  s_mul_i32 s58, s56, 1664525
  s_add_u32 s58, s58, 1013904223
  s_mul_i32 s59, s57, 22695477
  s_add_u32 s59, s59, 0x3c6ef35f
  v_mov_b32 v92, v90
  v_lshlrev_b32 v96, 4, v6
  v_mov_b32 v94, s58
  v_mov_b32 v95, s59
  s_lshr_b32 s41, s17, 6
  s_add_u32 s41, s41, 0xe80000
  s_cmp_ge_u32 s15, 4
  s_cselect_b32 s41, 0x1000000, s41
  s_mov_b32 exec_lo, 0x00010001
  s_mov_b32 exec_hi, 0x00010001
  buffer_store_dwordx4 v[92:95], v96, s[20:23], s41 offen sc1
  s_mov_b64 exec, -1
  s_lshr_b32 s38, s33, 4
  s_lshl_b32 s38, s38, 14
  s_bfe_u32 s39, s33, 0x30001
  s_lshl_b32 s39, s39, 10
  s_add_u32 s38, s38, s39
  s_add_u32 s38, s38, 0x400000
  s_and_b32 s39, s33, 1
  s_cmp_ge_u32 s15, 4
  s_cbranch_scc1 .Lrecurr_v7
  s_waitcnt lgkmcnt(14)
  v_mfma_f32_16x16x32_bf16 v[32:35], v[128:131], v[192:195], 0
  s_waitcnt lgkmcnt(14)
  v_mfma_f32_16x16x32_bf16 v[36:39], v[132:135], v[196:199], 0
  s_waitcnt lgkmcnt(13)
  v_mfma_f32_16x16x32_bf16 v[32:35], v[136:139], v[200:203], v[32:35]
  s_waitcnt lgkmcnt(12)
  v_mfma_f32_16x16x32_bf16 v[36:39], v[140:143], v[204:207], v[36:39]
  s_waitcnt lgkmcnt(11)
  v_mfma_f32_16x16x32_bf16 v[32:35], v[144:147], v[208:211], v[32:35]
  s_waitcnt lgkmcnt(10)
  v_mfma_f32_16x16x32_bf16 v[36:39], v[148:151], v[212:215], v[36:39]
  s_waitcnt lgkmcnt(9)
  v_mfma_f32_16x16x32_bf16 v[32:35], v[152:155], v[216:219], v[32:35]
  s_waitcnt lgkmcnt(8)
  v_mfma_f32_16x16x32_bf16 v[36:39], v[156:159], v[220:223], v[36:39]
  s_waitcnt lgkmcnt(7)
  v_mfma_f32_16x16x32_bf16 v[32:35], v[160:163], v[224:227], v[32:35]
  s_waitcnt lgkmcnt(6)
  v_mfma_f32_16x16x32_bf16 v[36:39], v[164:167], v[228:231], v[36:39]
  s_waitcnt lgkmcnt(5)
  v_mfma_f32_16x16x32_bf16 v[32:35], v[168:171], v[232:235], v[32:35]
  s_waitcnt lgkmcnt(4)
  v_mfma_f32_16x16x32_bf16 v[36:39], v[172:175], v[236:239], v[36:39]
  s_waitcnt lgkmcnt(3)
  v_mfma_f32_16x16x32_bf16 v[32:35], v[176:179], v[240:243], v[32:35]
  s_waitcnt lgkmcnt(2)
  v_mfma_f32_16x16x32_bf16 v[36:39], v[180:183], v[244:247], v[36:39]
  s_waitcnt lgkmcnt(1)
  v_mfma_f32_16x16x32_bf16 v[32:35], v[184:187], v[248:251], v[32:35]
  s_waitcnt lgkmcnt(0)
  v_mfma_f32_16x16x32_bf16 v[36:39], v[188:191], v[252:255], v[36:39]
  v_lshlrev_b32 v13, 4, v7
  v_and_b32 v14, 1, v6
  v_lshl_add_u32 v13, v14, 9, v13
  v_lshrrev_b32 v14, 1, v6
  v_lshl_add_u32 v13, v14, 3, v13
  s_lshl_b32 s39, s39, 8
  s_add_u32 s38, s38, s39
  s_branch .Lrecurr_st8
.Lrecurr_v7:
  s_waitcnt lgkmcnt(14)
  v_mfma_f32_16x16x32_bf16 v[32:35], v[192:195], v[128:131], 0
  s_waitcnt lgkmcnt(14)
  v_mfma_f32_16x16x32_bf16 v[36:39], v[196:199], v[132:135], 0
  s_waitcnt lgkmcnt(13)
  v_mfma_f32_16x16x32_bf16 v[32:35], v[200:203], v[136:139], v[32:35]
  s_waitcnt lgkmcnt(12)
  v_mfma_f32_16x16x32_bf16 v[36:39], v[204:207], v[140:143], v[36:39]
  s_waitcnt lgkmcnt(11)
  v_mfma_f32_16x16x32_bf16 v[32:35], v[208:211], v[144:147], v[32:35]
  s_waitcnt lgkmcnt(10)
  v_mfma_f32_16x16x32_bf16 v[36:39], v[212:215], v[148:151], v[36:39]
  s_waitcnt lgkmcnt(9)
  v_mfma_f32_16x16x32_bf16 v[32:35], v[216:219], v[152:155], v[32:35]
  s_waitcnt lgkmcnt(8)
  v_mfma_f32_16x16x32_bf16 v[36:39], v[220:223], v[156:159], v[36:39]
  s_waitcnt lgkmcnt(7)
  v_mfma_f32_16x16x32_bf16 v[32:35], v[224:227], v[160:163], v[32:35]
  s_waitcnt lgkmcnt(6)
  v_mfma_f32_16x16x32_bf16 v[36:39], v[228:231], v[164:167], v[36:39]
  s_waitcnt lgkmcnt(5)
  v_mfma_f32_16x16x32_bf16 v[32:35], v[232:235], v[168:171], v[32:35]
  s_waitcnt lgkmcnt(4)
  v_mfma_f32_16x16x32_bf16 v[36:39], v[236:239], v[172:175], v[36:39]
  s_waitcnt lgkmcnt(3)
  v_mfma_f32_16x16x32_bf16 v[32:35], v[240:243], v[176:179], v[32:35]
  s_waitcnt lgkmcnt(2)
  v_mfma_f32_16x16x32_bf16 v[36:39], v[244:247], v[180:183], v[36:39]
  s_waitcnt lgkmcnt(1)
  v_mfma_f32_16x16x32_bf16 v[32:35], v[248:251], v[184:187], v[32:35]
  s_waitcnt lgkmcnt(0)
  v_mfma_f32_16x16x32_bf16 v[36:39], v[252:255], v[188:191], v[36:39]
  v_lshlrev_b32 v13, 4, v7
  v_lshrrev_b32 v14, 1, v6
  v_lshl_add_u32 v13, v14, 8, v13
  v_and_b32 v14, 1, v6
  v_lshl_add_u32 v13, v14, 3, v13
  s_lshl_b32 s39, s39, 9
  s_add_u32 s38, s38, s39
  s_add_u32 s38, s38, 8192
.Lrecurr_st8:
  s_nop 0
  v_add_f32 v32, v32, v36
  v_add_f32 v33, v33, v37
  v_add_f32 v34, v34, v38
  v_add_f32 v35, v35, v39
  v_cvt_pk_bf16_f32 v32, v32, v33
  v_cvt_pk_bf16_f32 v33, v34, v35
  buffer_store_dwordx2 v[32:33], v13, s[20:23], s38 offen sc1
  s_mov_b32 s40, s37
  s_mov_b32 m0, s40
  s_add_u32 s40, s40, 4096
  buffer_load_dwordx4 v120, s[4:7], s34 offen offset:0 lds
  buffer_load_dwordx4 v121, s[4:7], s34 offen offset:1024 lds
  buffer_load_dwordx4 v122, s[4:7], s34 offen offset:2048 lds
  buffer_load_dwordx4 v123, s[4:7], s34 offen offset:3072 lds
  s_add_u32 s34, s34, 32768
  s_mov_b32 m0, s40
  s_add_u32 s40, s40, 4096
  buffer_load_dwordx4 v120, s[4:7], s34 offen offset:0 lds
  buffer_load_dwordx4 v121, s[4:7], s34 offen offset:1024 lds
  buffer_load_dwordx4 v122, s[4:7], s34 offen offset:2048 lds
  buffer_load_dwordx4 v123, s[4:7], s34 offen offset:3072 lds
  s_add_u32 s34, s34, 32768
  s_mov_b32 m0, s40
  s_add_u32 s40, s40, 4096
  buffer_load_dwordx4 v120, s[4:7], s34 offen offset:0 lds
  buffer_load_dwordx4 v121, s[4:7], s34 offen offset:1024 lds
  buffer_load_dwordx4 v122, s[4:7], s34 offen offset:2048 lds
  buffer_load_dwordx4 v123, s[4:7], s34 offen offset:3072 lds
  s_add_u32 s34, s34, 32768
  s_mov_b32 m0, s40
  s_add_u32 s40, s40, 4096
  buffer_load_dwordx4 v120, s[4:7], s34 offen offset:0 lds
  buffer_load_dwordx4 v121, s[4:7], s34 offen offset:1024 lds
  buffer_load_dwordx4 v122, s[4:7], s34 offen offset:2048 lds
  buffer_load_dwordx4 v123, s[4:7], s34 offen offset:3072 lds
  s_add_u32 s34, s34, 32768
  s_lshr_b32 s38, s15, 2
  s_lshl_b32 s38, s38, 10
  s_bfe_u32 s39, s33, 0x10003
  s_lshl_b32 s39, s39, 9
  s_add_u32 s38, s38, s39
  s_lshr_b32 s39, s33, 4
  s_lshl_b32 s39, s39, 6
  s_add_u32 s38, s38, s39
  s_and_b32 s39, s33, 7
  s_lshl_b32 s39, s39, 3
  s_add_u32 s38, s38, s39
  s_add_u32 s38, s38, 0xe00000
  v_mov_b32 v28, s58
  v_mov_b32 v29, s59
  v_lshlrev_b32 v30, 3, v2
  s_waitcnt vmcnt(16)
  s_mov_b64 exec, 1
  buffer_store_dwordx2 v[28:29], v30, s[20:23], s38 offen sc1
  s_mov_b64 exec, -1
  s_waitcnt vmcnt(1)
  s_branch .Lrecurr_q5
.Lrecurr_q16:
  s_waitcnt vmcnt(0)
  v_readfirstlane_b32 s56, v98
  v_readfirstlane_b32 s57, v99
  s_mul_i32 s58, s56, 1664525
  s_add_u32 s58, s58, 1013904223
  s_mul_i32 s59, s57, 22695477
  s_add_u32 s59, s59, 0x3c6ef35f
  v_mov_b32 v92, v90
  v_lshlrev_b32 v96, 4, v6
  v_mov_b32 v94, s58
  v_mov_b32 v95, s59
  s_lshr_b32 s41, s17, 6
  s_add_u32 s41, s41, 0xe80000
  s_cmp_ge_u32 s15, 4
  s_cselect_b32 s41, 0x1000000, s41
  s_mov_b32 exec_lo, 0x00010001
  s_mov_b32 exec_hi, 0x00010001
  buffer_store_dwordx4 v[92:95], v96, s[20:23], s41 offen sc1
  s_mov_b64 exec, -1
  s_mov_b32 s40, s37
  s_mov_b32 m0, s40
  s_add_u32 s40, s40, 4096
  buffer_load_dwordx4 v120, s[4:7], s34 offen offset:0 lds
  buffer_load_dwordx4 v121, s[4:7], s34 offen offset:1024 lds
  buffer_load_dwordx4 v122, s[4:7], s34 offen offset:2048 lds
  buffer_load_dwordx4 v123, s[4:7], s34 offen offset:3072 lds
  s_add_u32 s34, s34, 32768
  s_mov_b32 m0, s40
  s_add_u32 s40, s40, 4096
  buffer_load_dwordx4 v120, s[4:7], s34 offen offset:0 lds
  buffer_load_dwordx4 v121, s[4:7], s34 offen offset:1024 lds
  buffer_load_dwordx4 v122, s[4:7], s34 offen offset:2048 lds
  buffer_load_dwordx4 v123, s[4:7], s34 offen offset:3072 lds
  s_add_u32 s34, s34, 32768
  s_mov_b32 m0, s40
  s_add_u32 s40, s40, 4096
  buffer_load_dwordx4 v120, s[4:7], s34 offen offset:0 lds
  buffer_load_dwordx4 v121, s[4:7], s34 offen offset:1024 lds
  buffer_load_dwordx4 v122, s[4:7], s34 offen offset:2048 lds
  buffer_load_dwordx4 v123, s[4:7], s34 offen offset:3072 lds
  s_add_u32 s34, s34, 32768
  s_mov_b32 m0, s40
  s_add_u32 s40, s40, 4096
  buffer_load_dwordx4 v120, s[4:7], s34 offen offset:0 lds
  buffer_load_dwordx4 v121, s[4:7], s34 offen offset:1024 lds
  buffer_load_dwordx4 v122, s[4:7], s34 offen offset:2048 lds
  buffer_load_dwordx4 v123, s[4:7], s34 offen offset:3072 lds
  s_add_u32 s34, s34, 32768
  s_waitcnt vmcnt(0)
.Lrecurr_q5:
  ds_read_b64_tr_b16 v[48:49], v125 offset:0
  ds_read_b64_tr_b16 v[50:51], v125 offset:512
  ds_read_b64_tr_b16 v[52:53], v126 offset:0
  ds_read_b64_tr_b16 v[54:55], v126 offset:512
  ds_read_b64_tr_b16 v[56:57], v125 offset:2048
  ds_read_b64_tr_b16 v[58:59], v125 offset:2560
  ds_read_b64_tr_b16 v[60:61], v126 offset:2048
  ds_read_b64_tr_b16 v[62:63], v126 offset:2560
  ds_read_b64_tr_b16 v[64:65], v125 offset:4096
  ds_read_b64_tr_b16 v[66:67], v125 offset:4608
  ds_read_b64_tr_b16 v[68:69], v126 offset:4096
  ds_read_b64_tr_b16 v[70:71], v126 offset:4608
  ds_read_b64_tr_b16 v[72:73], v125 offset:6144
  ds_read_b64_tr_b16 v[74:75], v125 offset:6656
  ds_read_b64_tr_b16 v[76:77], v126 offset:6144
  ds_read_b64_tr_b16 v[78:79], v126 offset:6656
  ds_read_b64_tr_b16 v[80:81], v125 offset:8192
  ds_read_b64_tr_b16 v[82:83], v125 offset:8704
  ds_read_b64_tr_b16 v[84:85], v126 offset:8192
  ds_read_b64_tr_b16 v[86:87], v126 offset:8704
  ds_read_b64_tr_b16 v[88:89], v125 offset:10240
  ds_read_b64_tr_b16 v[90:91], v125 offset:10752
  ds_read_b64_tr_b16 v[92:93], v126 offset:10240
  ds_read_b64_tr_b16 v[94:95], v126 offset:10752
  ds_read_b64_tr_b16 v[96:97], v125 offset:12288
  ds_read_b64_tr_b16 v[98:99], v125 offset:12800
  ds_read_b64_tr_b16 v[100:101], v126 offset:12288
  ds_read_b64_tr_b16 v[102:103], v126 offset:12800
  ds_read_b64_tr_b16 v[104:105], v125 offset:14336
  ds_read_b64_tr_b16 v[106:107], v125 offset:14848
  ds_read_b64_tr_b16 v[108:109], v126 offset:14336
  ds_read_b64_tr_b16 v[110:111], v126 offset:14848
  s_waitcnt lgkmcnt(0)
  s_mov_b32 s40, s37
  s_mov_b32 m0, s40
  s_add_u32 s40, s40, 4096
  buffer_load_dwordx4 v112, s[44:47], s35 offen offset:0 lds
  buffer_load_dwordx4 v113, s[44:47], s35 offen offset:1024 lds
  buffer_load_dwordx4 v114, s[44:47], s35 offen offset:2048 lds
  buffer_load_dwordx4 v115, s[44:47], s35 offen offset:3072 lds
  s_add_u32 s35, s35, 16384
  s_mov_b32 m0, s40
  s_add_u32 s40, s40, 4096
  buffer_load_dwordx4 v112, s[44:47], s35 offen offset:0 lds
  buffer_load_dwordx4 v113, s[44:47], s35 offen offset:1024 lds
  buffer_load_dwordx4 v114, s[44:47], s35 offen offset:2048 lds
  buffer_load_dwordx4 v115, s[44:47], s35 offen offset:3072 lds
  s_add_u32 s35, s35, 16384
  s_mov_b32 m0, s40
  s_add_u32 s40, s40, 4096
  buffer_load_dwordx4 v112, s[44:47], s35 offen offset:0 lds
  buffer_load_dwordx4 v113, s[44:47], s35 offen offset:1024 lds
  buffer_load_dwordx4 v114, s[44:47], s35 offen offset:2048 lds
  buffer_load_dwordx4 v115, s[44:47], s35 offen offset:3072 lds
  s_add_u32 s35, s35, 16384
  s_mov_b32 m0, s40
  s_add_u32 s40, s40, 4096
  buffer_load_dwordx4 v112, s[44:47], s35 offen offset:0 lds
  buffer_load_dwordx4 v113, s[44:47], s35 offen offset:1024 lds
  buffer_load_dwordx4 v114, s[44:47], s35 offen offset:2048 lds
  buffer_load_dwordx4 v115, s[44:47], s35 offen offset:3072 lds
  s_add_u32 s35, s35, 16384
  v_lshlrev_b32 v8, 4, v4
  s_lshl_b32 s41, s14, 10
  s_add_u32 s41, s41, 0xe80000
  buffer_load_dwordx4 v[32:35], v8, s[20:23], s41 offen sc1
  buffer_load_dwordx4 v[36:39], v8, s[20:23], s41 offen offset:512 sc1
  v_lshrrev_b32 v9, 4, v2
  v_lshrrev_b32 v10, 2, v2
  v_xor_b32 v9, v9, v10
  v_and_b32 v9, 1, v9
  v_cmp_eq_u32 vcc, 0, v9
  v_mov_b32 v9, 0x3f803f80
  s_nop 0
  v_cndmask_b32 v16, 0, v9, vcc
  v_cndmask_b32 v17, 0, v9, vcc
  v_cndmask_b32 v18, 0, v9, vcc
  v_cndmask_b32 v19, 0, v9, vcc
  s_nop 1
  v_mfma_f32_16x16x32_bf16 v[20:23], v[16:19], v[48:51], 0
  v_mfma_f32_16x16x32_bf16 v[24:27], v[16:19], v[52:55], 0
  v_mfma_f32_16x16x32_bf16 v[20:23], v[16:19], v[56:59], v[20:23]
  v_mfma_f32_16x16x32_bf16 v[24:27], v[16:19], v[60:63], v[24:27]
  v_mfma_f32_16x16x32_bf16 v[20:23], v[16:19], v[64:67], v[20:23]
  v_mfma_f32_16x16x32_bf16 v[24:27], v[16:19], v[68:71], v[24:27]
  v_mfma_f32_16x16x32_bf16 v[20:23], v[16:19], v[72:75], v[20:23]
  v_mfma_f32_16x16x32_bf16 v[24:27], v[16:19], v[76:79], v[24:27]
  v_mfma_f32_16x16x32_bf16 v[20:23], v[16:19], v[80:83], v[20:23]
  v_mfma_f32_16x16x32_bf16 v[24:27], v[16:19], v[84:87], v[24:27]
  v_mfma_f32_16x16x32_bf16 v[20:23], v[16:19], v[88:91], v[20:23]
  v_mfma_f32_16x16x32_bf16 v[24:27], v[16:19], v[92:95], v[24:27]
  v_mfma_f32_16x16x32_bf16 v[20:23], v[16:19], v[96:99], v[20:23]
  v_mfma_f32_16x16x32_bf16 v[24:27], v[16:19], v[100:103], v[24:27]
  v_mfma_f32_16x16x32_bf16 v[20:23], v[16:19], v[104:107], v[20:23]
  v_mfma_f32_16x16x32_bf16 v[24:27], v[16:19], v[108:111], v[24:27]
  v_mov_b32 v3, 0xdddd
  s_lshl_b32 s17, s14, 16
  s_lshl_b32 s18, s15, 12
  s_add_u32 s17, s17, s18
  s_lshl_b32 s18, s16, 10
  s_add_u32 s17, s17, s18
  s_add_u32 s24, s12, 0x400000
  s_addc_u32 s25, s13, 0
  s_mov_b32 s26, 0x20000
  s_mov_b32 s27, 0x20000
  v_add_u32 v127, s37, v12
  s_lshl_b32 s40, s16, 11
  s_add_u32 s40, s40, 16384
  v_add_u32 v119, s40, v12
  v_cmp_lt_u32 vcc, 31, v2
  v_cvt_pk_bf16_f32 v21, v20, v20
  v_and_b32 v21, s36, v21
  v_sub_f32 v20, v20, v21
  v_cndmask_b32 v20, v21, v20, vcc
  v_cvt_pk_bf16_f32 v20, v20, 0
  v_mov_b32 v21, 0
  v_mov_b32 v22, 0
  v_mov_b32 v23, 0
  v_cvt_pk_bf16_f32 v25, v24, v24
  v_and_b32 v25, s36, v25
  v_sub_f32 v24, v24, v25
  v_cndmask_b32 v24, v25, v24, vcc
  v_cvt_pk_bf16_f32 v24, v24, 0
  v_mov_b32 v25, 0
  v_mov_b32 v26, 0
  v_mov_b32 v27, 0
  v_xor_b32 v41, 32, v124
  v_xor_b32 v42, 64, v124
  v_xor_b32 v43, 96, v124
  v_xor_b32 v44, 128, v124
  v_xor_b32 v45, 160, v124
  v_xor_b32 v46, 192, v124
  v_xor_b32 v47, 224, v124
  s_waitcnt vmcnt(2)
  ds_read_b128 v[128:131], v124 offset:0
  ds_read_b128 v[132:135], v124 offset:8192
  ds_read_b128 v[136:139], v41 offset:0
  ds_read_b128 v[140:143], v41 offset:8192
  ds_read_b128 v[144:147], v42 offset:0
  ds_read_b128 v[148:151], v42 offset:8192
  ds_read_b128 v[152:155], v43 offset:0
  ds_read_b128 v[156:159], v43 offset:8192
  ds_read_b128 v[160:163], v44 offset:0
  ds_read_b128 v[164:167], v44 offset:8192
  ds_read_b128 v[168:171], v45 offset:0
  ds_read_b128 v[172:175], v45 offset:8192
  ds_read_b128 v[176:179], v46 offset:0
  ds_read_b128 v[180:183], v46 offset:8192
  ds_read_b128 v[184:187], v47 offset:0
  ds_read_b128 v[188:191], v47 offset:8192
  s_waitcnt lgkmcnt(14)
  v_mfma_f32_32x32x16_bf16 v[192:207], v[48:51], v[128:131], 0
  v_mfma_f32_32x32x16_bf16 v[208:223], v[52:55], v[128:131], 0
  v_mfma_f32_32x32x16_bf16 v[224:239], v[48:51], v[132:135], 0
  v_mfma_f32_32x32x16_bf16 v[240:255], v[52:55], v[132:135], 0
  s_waitcnt lgkmcnt(12)
  v_mfma_f32_32x32x16_bf16 v[192:207], v[56:59], v[136:139], v[192:207]
  v_mfma_f32_32x32x16_bf16 v[208:223], v[60:63], v[136:139], v[208:223]
  v_mfma_f32_32x32x16_bf16 v[224:239], v[56:59], v[140:143], v[224:239]
  v_mfma_f32_32x32x16_bf16 v[240:255], v[60:63], v[140:143], v[240:255]
  s_waitcnt lgkmcnt(10)
  v_mfma_f32_32x32x16_bf16 v[192:207], v[64:67], v[144:147], v[192:207]
  v_mfma_f32_32x32x16_bf16 v[208:223], v[68:71], v[144:147], v[208:223]
  v_mfma_f32_32x32x16_bf16 v[224:239], v[64:67], v[148:151], v[224:239]
  v_mfma_f32_32x32x16_bf16 v[240:255], v[68:71], v[148:151], v[240:255]
  s_waitcnt lgkmcnt(8)
  v_mfma_f32_32x32x16_bf16 v[192:207], v[72:75], v[152:155], v[192:207]
  v_mfma_f32_32x32x16_bf16 v[208:223], v[76:79], v[152:155], v[208:223]
  v_mfma_f32_32x32x16_bf16 v[224:239], v[72:75], v[156:159], v[224:239]
  v_mfma_f32_32x32x16_bf16 v[240:255], v[76:79], v[156:159], v[240:255]
  s_waitcnt lgkmcnt(6)
  v_mfma_f32_32x32x16_bf16 v[192:207], v[80:83], v[160:163], v[192:207]
  v_mfma_f32_32x32x16_bf16 v[208:223], v[84:87], v[160:163], v[208:223]
  v_mfma_f32_32x32x16_bf16 v[224:239], v[80:83], v[164:167], v[224:239]
  v_mfma_f32_32x32x16_bf16 v[240:255], v[84:87], v[164:167], v[240:255]
  s_waitcnt lgkmcnt(4)
  v_mfma_f32_32x32x16_bf16 v[192:207], v[88:91], v[168:171], v[192:207]
  v_mfma_f32_32x32x16_bf16 v[208:223], v[92:95], v[168:171], v[208:223]
  v_mfma_f32_32x32x16_bf16 v[224:239], v[88:91], v[172:175], v[224:239]
  v_mfma_f32_32x32x16_bf16 v[240:255], v[92:95], v[172:175], v[240:255]
  s_waitcnt lgkmcnt(2)
  v_mfma_f32_32x32x16_bf16 v[192:207], v[96:99], v[176:179], v[192:207]
  v_mfma_f32_32x32x16_bf16 v[208:223], v[100:103], v[176:179], v[208:223]
  v_mfma_f32_32x32x16_bf16 v[224:239], v[96:99], v[180:183], v[224:239]
  v_mfma_f32_32x32x16_bf16 v[240:255], v[100:103], v[180:183], v[240:255]
  s_waitcnt lgkmcnt(0)
  v_mfma_f32_32x32x16_bf16 v[192:207], v[104:107], v[184:187], v[192:207]
  v_mfma_f32_32x32x16_bf16 v[208:223], v[108:111], v[184:187], v[208:223]
  v_mfma_f32_32x32x16_bf16 v[224:239], v[104:107], v[188:191], v[224:239]
  v_mfma_f32_32x32x16_bf16 v[240:255], v[108:111], v[188:191], v[240:255]
  v_lshlrev_b32 v9, 3, v2
  s_lshl_b32 s42, s16, 9
  s_add_u32 s42, s42, 0xe00000
  s_mov_b32 s60, 0x40000
.Lrecurr_stp9:
  s_waitcnt vmcnt(0)
  v_cmp_eq_u64 vcc, s[58:59], v[34:35]
  v_cmp_eq_u64 s[62:63], s[58:59], v[38:39]
  s_and_b64 vcc, vcc, s[62:63]
  s_cmp_eq_u64 vcc, -1
  s_cbranch_scc1 .Lrecurr_stpd10
  s_sleep 2
  buffer_load_dwordx4 v[32:35], v8, s[20:23], s41 offen sc1
  buffer_load_dwordx4 v[36:39], v8, s[20:23], s41 offen offset:512 sc1
  s_sub_u32 s60, s60, 1
  s_cmp_lg_u32 s60, 0
  s_cbranch_scc1 .Lrecurr_stp9
  s_waitcnt vmcnt(0)
.Lrecurr_stpd10:
  s_mov_b32 s40, 0x3eb8aa3b
  v_lshrrev_b32 v40, 16, v32
  v_mov_b32 v41, 0
  v_mov_b32 v42, 0
  v_mov_b32 v43, 0
  v_rcp_f32 v34, v33
  v_lshrrev_b32 v44, 16, v36
  v_mov_b32 v45, 0
  v_mov_b32 v46, 0
  v_mov_b32 v47, 0
  v_rcp_f32 v38, v37
  v_mul_f32 v34, s40, v34
  v_mov_b32 v35, v34
  v_mul_f32 v38, s40, v38
  v_mov_b32 v39, v38
  v_mfma_f32_32x32x16_bf16 v[192:207], v[20:23], v[40:43], v[192:207]
  v_mfma_f32_32x32x16_bf16 v[208:223], v[24:27], v[40:43], v[208:223]
  v_mfma_f32_32x32x16_bf16 v[224:239], v[20:23], v[44:47], v[224:239]
  v_mfma_f32_32x32x16_bf16 v[240:255], v[24:27], v[44:47], v[240:255]
  buffer_load_dwordx2 v[116:117], v9, s[20:23], s42 offen sc1
  s_nop 7
  ds_write_b128 v127, v[192:195] offset:0
  ds_write_b128 v127, v[196:199] offset:1024
  ds_write_b128 v127, v[200:203] offset:2048
  ds_write_b128 v127, v[204:207] offset:3072
  ds_write_b128 v127, v[208:211] offset:4096
  ds_write_b128 v127, v[212:215] offset:5120
  ds_write_b128 v127, v[216:219] offset:6144
  ds_write_b128 v127, v[220:223] offset:7168
  ds_write_b128 v127, v[224:227] offset:8192
  ds_write_b128 v127, v[228:231] offset:9216
  ds_write_b128 v127, v[232:235] offset:10240
  ds_write_b128 v127, v[236:239] offset:11264
  ds_write_b128 v127, v[240:243] offset:12288
  ds_write_b128 v127, v[244:247] offset:13312
  ds_write_b128 v127, v[248:251] offset:14336
  ds_write_b128 v127, v[252:255] offset:15360
  s_waitcnt lgkmcnt(0)
  s_barrier
  ds_read_b128 v[128:131], v119 offset:0
  ds_read_b128 v[132:135], v119 offset:1024
  ds_read_b128 v[136:139], v119 offset:16384
  ds_read_b128 v[140:143], v119 offset:17408
  ds_read_b128 v[144:147], v119 offset:32768
  ds_read_b128 v[148:151], v119 offset:33792
  ds_read_b128 v[152:155], v119 offset:49152
  ds_read_b128 v[156:159], v119 offset:50176
  ds_read_b128 v[160:163], v119 offset:8192
  ds_read_b128 v[164:167], v119 offset:9216
  ds_read_b128 v[168:171], v119 offset:24576
  ds_read_b128 v[172:175], v119 offset:25600
  ds_read_b128 v[176:179], v119 offset:40960
  ds_read_b128 v[180:183], v119 offset:41984
  ds_read_b128 v[184:187], v119 offset:57344
  ds_read_b128 v[188:191], v119 offset:58368
  s_mov_b32 s60, 0x40000
.Lrecurr_kvp11:
  s_waitcnt vmcnt(0)
  v_cmp_eq_u64 vcc, s[58:59], v[116:117]
  s_cmp_eq_u64 vcc, -1
  s_cbranch_scc1 .Lrecurr_kvpd12
  s_sleep 4
  buffer_load_dwordx2 v[116:117], v9, s[20:23], s42 offen sc1
  s_sub_u32 s60, s60, 1
  s_cmp_lg_u32 s60, 0
  s_cbranch_scc1 .Lrecurr_kvp11
  s_waitcnt vmcnt(0)
.Lrecurr_kvpd12:
  s_mov_b32 m0, s19
  s_nop 0
  buffer_load_dwordx4 v12, s[24:27], s19 offen offset:0 sc1 lds
  buffer_load_dwordx4 v12, s[24:27], s19 offen offset:1024 sc1 lds
  buffer_load_dwordx4 v12, s[24:27], s19 offen offset:2048 sc1 lds
  buffer_load_dwordx4 v12, s[24:27], s19 offen offset:3072 sc1 lds
  v_mov_b32 v48, 0
  v_mov_b32 v64, 0
  v_mov_b32 v49, 0
  v_mov_b32 v65, 0
  v_mov_b32 v50, 0
  v_mov_b32 v66, 0
  v_mov_b32 v51, 0
  v_mov_b32 v67, 0
  v_mov_b32 v52, 0
  v_mov_b32 v68, 0
  v_mov_b32 v53, 0
  v_mov_b32 v69, 0
  v_mov_b32 v54, 0
  v_mov_b32 v70, 0
  v_mov_b32 v55, 0
  v_mov_b32 v71, 0
  v_mov_b32 v56, 0
  v_mov_b32 v72, 0
  v_mov_b32 v57, 0
  v_mov_b32 v73, 0
  v_mov_b32 v58, 0
  v_mov_b32 v74, 0
  v_mov_b32 v59, 0
  v_mov_b32 v75, 0
  v_mov_b32 v60, 0
  v_mov_b32 v76, 0
  v_mov_b32 v61, 0
  v_mov_b32 v77, 0
  v_mov_b32 v62, 0
  v_mov_b32 v78, 0
  v_mov_b32 v63, 0
  v_mov_b32 v79, 0
  v_and_b32 v13, 11, v2
  v_cmp_eq_u32 vcc, 0, v13
  v_mov_b32 v13, 0x3f803f80
  s_lshl_b32 s18, s16, 11
  s_add_u32 s18, s18, 65536
  v_cndmask_b32 v16, 0, v13, vcc
  v_cndmask_b32 v17, 0, v13, vcc
  v_cndmask_b32 v18, 0, v13, vcc
  v_cndmask_b32 v19, 0, v13, vcc
  v_add_u32 v15, s18, v12
  s_waitcnt lgkmcnt(0)
  s_barrier
  ds_write_b128 v15, v[16:19]
  ds_write_b128 v15, v[16:19] offset:1024
  v_add_f32 v128, v128, v136
  v_add_f32 v129, v129, v137
  v_add_f32 v144, v144, v152
  v_add_f32 v145, v145, v153
  v_add_f32 v130, v130, v138
  v_add_f32 v131, v131, v139
  v_add_f32 v146, v146, v154
  v_add_f32 v147, v147, v155
  v_add_f32 v132, v132, v140
  v_add_f32 v133, v133, v141
  v_add_f32 v148, v148, v156
  v_add_f32 v149, v149, v157
  v_add_f32 v134, v134, v142
  v_add_f32 v135, v135, v143
  v_add_f32 v150, v150, v158
  v_add_f32 v151, v151, v159
  v_add_f32 v128, v128, v144
  v_add_f32 v129, v129, v145
  v_add_f32 v130, v130, v146
  v_add_f32 v131, v131, v147
  v_add_f32 v132, v132, v148
  v_add_f32 v133, v133, v149
  v_add_f32 v134, v134, v150
  v_add_f32 v135, v135, v151
  v_mul_f32 v128, v128, v34
  v_mul_f32 v129, v129, v35
  v_mul_f32 v130, v130, v34
  v_mul_f32 v131, v131, v35
  v_mul_f32 v132, v132, v34
  v_mul_f32 v133, v133, v35
  v_mul_f32 v134, v134, v34
  v_mul_f32 v135, v135, v35
  v_cvt_pk_bf16_f32 v4, v128, v129
  v_cvt_pk_bf16_f32 v5, v130, v131
  v_cvt_pk_bf16_f32 v6, v132, v133
  v_cvt_pk_bf16_f32 v7, v134, v135
  v_add_f32 v160, v160, v168
  v_add_f32 v161, v161, v169
  v_add_f32 v176, v176, v184
  v_add_f32 v177, v177, v185
  v_add_f32 v162, v162, v170
  v_add_f32 v163, v163, v171
  v_add_f32 v178, v178, v186
  v_add_f32 v179, v179, v187
  v_add_f32 v164, v164, v172
  v_add_f32 v165, v165, v173
  v_add_f32 v180, v180, v188
  v_add_f32 v181, v181, v189
  v_add_f32 v166, v166, v174
  v_add_f32 v167, v167, v175
  v_add_f32 v182, v182, v190
  v_add_f32 v183, v183, v191
  v_add_f32 v160, v160, v176
  v_add_f32 v161, v161, v177
  v_add_f32 v162, v162, v178
  v_add_f32 v163, v163, v179
  v_add_f32 v164, v164, v180
  v_add_f32 v165, v165, v181
  v_add_f32 v166, v166, v182
  v_add_f32 v167, v167, v183
  v_mul_f32 v160, v160, v38
  v_mul_f32 v161, v161, v39
  v_mul_f32 v162, v162, v38
  v_mul_f32 v163, v163, v39
  v_mul_f32 v164, v164, v38
  v_mul_f32 v165, v165, v39
  v_mul_f32 v166, v166, v38
  v_mul_f32 v167, v167, v39
  v_cvt_pk_bf16_f32 v8, v160, v161
  v_cvt_pk_bf16_f32 v9, v162, v163
  v_cvt_pk_bf16_f32 v10, v164, v165
  v_cvt_pk_bf16_f32 v11, v166, v167
  s_add_u32 s30, s19, 16384
  s_mov_b32 m0, s30
  s_nop 0
  buffer_load_dwordx4 v12, s[24:27], s30 offen offset:0 sc1 lds
  buffer_load_dwordx4 v12, s[24:27], s30 offen offset:1024 sc1 lds
  buffer_load_dwordx4 v12, s[24:27], s30 offen offset:2048 sc1 lds
  buffer_load_dwordx4 v12, s[24:27], s30 offen offset:3072 sc1 lds
  s_add_u32 s30, s30, 16384
  v_and_b32 v13, 15, v2
  v_lshlrev_b32 v13, 4, v13
  v_lshrrev_b32 v14, 5, v2
  v_lshl_add_u32 v13, v14, 8, v13
  v_bfe_u32 v14, v2, 4, 1
  v_mov_b32 v15, 57344
  v_mad_u32_u24 v13, v14, v15, v13
  v_xor_b32 v14, 1, v14
  v_mov_b32 v104, v12
  v_add_u32 v105, 16384, v12
  v_mov_b32 v106, v13
  s_mov_b32 s31, 16384
  v_mad_u32_u24 v107, v14, s31, v13
  s_mov_b32 s49, 57344
  s_lshr_b32 s42, s3, 3
  s_mul_i32 s48, s16, 24576
  s_cmp_eq_u32 s16, 3
  s_cselect_b32 s44, s52, s50
  s_cselect_b32 s45, s53, s51
  s_cselect_b32 s43, 16384, s49
  s_cselect_b32 s48, 0, s48
  s_mul_i32 s42, s42, s43
  s_add_u32 s46, s42, s43
  s_add_u32 s42, s42, s48
  s_add_u32 s43, s42, 24576
  s_min_u32 s46, s46, s43
  s_mov_b32 s47, 0x20000
  v_lshlrev_b32 v108, 7, v2
  s_waitcnt vmcnt(4) lgkmcnt(0)
  s_barrier
  ds_read_b128 v[80:83], v104 offset:0
  ds_read_b128 v[84:87], v104 offset:1024
  ds_read_b128 v[88:91], v106 offset:8192
  ds_read_b128 v[92:95], v106 offset:8704
  s_waitcnt lgkmcnt(3)
  v_mfma_f32_32x32x16_bf16 v[16:31], v[80:83], v[4:7], 0
  v_mfma_f32_32x32x16_bf16 v[32:47], v[80:83], v[8:11], 0
  s_nop 10
  v_exp_f32 v16, v16
  v_exp_f32 v17, v17
  v_exp_f32 v18, v18
  v_exp_f32 v19, v19
  v_exp_f32 v20, v20
  s_mov_b32 s33, 8
  s_setprio 1
.Lrecurr_aloop13:
  v_exp_f32 v21, v21
  v_exp_f32 v22, v22
  s_waitcnt lgkmcnt(0)
  ds_read_b128 v[96:99], v106 offset:9216
  ds_read_b128 v[100:103], v106 offset:9728
  v_exp_f32 v23, v23
  v_exp_f32 v24, v24
  v_exp_f32 v25, v25
  v_exp_f32 v26, v26
  v_exp_f32 v27, v27
  v_exp_f32 v28, v28
  v_exp_f32 v29, v29
  v_exp_f32 v30, v30
  v_smfmac_f32_32x32x32_bf16 v[48:63], v[88:91], v[16:23], v3
  v_exp_f32 v31, v31
  v_exp_f32 v32, v32
  v_exp_f32 v33, v33
  v_smfmac_f32_32x32x32_bf16 v[48:63], v[92:95], v[24:31], v3
  v_exp_f32 v34, v34
  v_exp_f32 v35, v35
  v_exp_f32 v36, v36
  v_mfma_f32_32x32x16_bf16 v[16:31], v[84:87], v[4:7], 0
  v_exp_f32 v37, v37
  v_exp_f32 v38, v38
  ds_read_b128 v[80:83], v104 offset:2048
  v_exp_f32 v39, v39
  v_exp_f32 v40, v40
  v_exp_f32 v41, v41
  v_exp_f32 v42, v42
  v_exp_f32 v43, v43
  v_exp_f32 v44, v44
  v_exp_f32 v45, v45
  v_exp_f32 v46, v46
  v_smfmac_f32_32x32x32_bf16 v[64:79], v[88:91], v[32:39], v3
  v_exp_f32 v47, v47
  v_exp_f32 v16, v16
  v_exp_f32 v17, v17
  v_smfmac_f32_32x32x32_bf16 v[64:79], v[92:95], v[40:47], v3
  v_exp_f32 v18, v18
  v_exp_f32 v19, v19
  v_exp_f32 v20, v20
  v_mfma_f32_32x32x16_bf16 v[32:47], v[84:87], v[8:11], 0
  v_exp_f32 v21, v21
  v_exp_f32 v22, v22
  s_waitcnt lgkmcnt(0)
  ds_read_b128 v[88:91], v106 offset:10240
  ds_read_b128 v[92:95], v106 offset:10752
  v_exp_f32 v23, v23
  v_exp_f32 v24, v24
  v_exp_f32 v25, v25
  v_exp_f32 v26, v26
  v_exp_f32 v27, v27
  v_exp_f32 v28, v28
  v_exp_f32 v29, v29
  v_exp_f32 v30, v30
  v_smfmac_f32_32x32x32_bf16 v[48:63], v[96:99], v[16:23], v3
  v_exp_f32 v31, v31
  v_exp_f32 v32, v32
  v_exp_f32 v33, v33
  v_smfmac_f32_32x32x32_bf16 v[48:63], v[100:103], v[24:31], v3
  v_exp_f32 v34, v34
  v_exp_f32 v35, v35
  v_exp_f32 v36, v36
  v_mfma_f32_32x32x16_bf16 v[16:31], v[80:83], v[4:7], 0
  v_exp_f32 v37, v37
  v_exp_f32 v38, v38
  ds_read_b128 v[84:87], v104 offset:3072
  v_exp_f32 v39, v39
  v_exp_f32 v40, v40
  v_exp_f32 v41, v41
  v_exp_f32 v42, v42
  v_exp_f32 v43, v43
  v_exp_f32 v44, v44
  v_exp_f32 v45, v45
  v_exp_f32 v46, v46
  v_smfmac_f32_32x32x32_bf16 v[64:79], v[96:99], v[32:39], v3
  v_exp_f32 v47, v47
  v_exp_f32 v16, v16
  v_exp_f32 v17, v17
  v_smfmac_f32_32x32x32_bf16 v[64:79], v[100:103], v[40:47], v3
  v_exp_f32 v18, v18
  v_exp_f32 v19, v19
  v_exp_f32 v20, v20
  v_mfma_f32_32x32x16_bf16 v[32:47], v[80:83], v[8:11], 0
  v_exp_f32 v21, v21
  v_exp_f32 v22, v22
  s_waitcnt lgkmcnt(0)
  ds_read_b128 v[96:99], v106 offset:11264
  ds_read_b128 v[100:103], v106 offset:11776
  v_exp_f32 v23, v23
  v_exp_f32 v24, v24
  v_exp_f32 v25, v25
  v_exp_f32 v26, v26
  v_exp_f32 v27, v27
  v_exp_f32 v28, v28
  v_exp_f32 v29, v29
  v_exp_f32 v30, v30
  v_smfmac_f32_32x32x32_bf16 v[48:63], v[88:91], v[16:23], v3
  v_exp_f32 v31, v31
  v_exp_f32 v32, v32
  v_exp_f32 v33, v33
  v_smfmac_f32_32x32x32_bf16 v[48:63], v[92:95], v[24:31], v3
  v_exp_f32 v34, v34
  v_exp_f32 v35, v35
  v_exp_f32 v36, v36
  v_mfma_f32_32x32x16_bf16 v[16:31], v[84:87], v[4:7], 0
  v_exp_f32 v37, v37
  v_exp_f32 v38, v38
  ds_read_b128 v[80:83], v104 offset:4096
  v_exp_f32 v39, v39
  v_exp_f32 v40, v40
  v_exp_f32 v41, v41
  v_exp_f32 v42, v42
  v_exp_f32 v43, v43
  v_exp_f32 v44, v44
  v_exp_f32 v45, v45
  v_exp_f32 v46, v46
  v_smfmac_f32_32x32x32_bf16 v[64:79], v[88:91], v[32:39], v3
  v_exp_f32 v47, v47
  v_exp_f32 v16, v16
  v_exp_f32 v17, v17
  v_smfmac_f32_32x32x32_bf16 v[64:79], v[92:95], v[40:47], v3
  v_exp_f32 v18, v18
  v_exp_f32 v19, v19
  v_exp_f32 v20, v20
  v_mfma_f32_32x32x16_bf16 v[32:47], v[84:87], v[8:11], 0
  v_exp_f32 v21, v21
  v_exp_f32 v22, v22
  s_waitcnt lgkmcnt(0)
  ds_read_b128 v[88:91], v106 offset:12288
  ds_read_b128 v[92:95], v106 offset:12800
  v_exp_f32 v23, v23
  v_exp_f32 v24, v24
  v_exp_f32 v25, v25
  v_exp_f32 v26, v26
  v_exp_f32 v27, v27
  v_exp_f32 v28, v28
  v_exp_f32 v29, v29
  v_exp_f32 v30, v30
  v_smfmac_f32_32x32x32_bf16 v[48:63], v[96:99], v[16:23], v3
  v_exp_f32 v31, v31
  v_exp_f32 v32, v32
  v_exp_f32 v33, v33
  v_smfmac_f32_32x32x32_bf16 v[48:63], v[100:103], v[24:31], v3
  v_exp_f32 v34, v34
  v_exp_f32 v35, v35
  v_exp_f32 v36, v36
  v_mfma_f32_32x32x16_bf16 v[16:31], v[80:83], v[4:7], 0
  v_exp_f32 v37, v37
  v_exp_f32 v38, v38
  ds_read_b128 v[84:87], v104 offset:5120
  v_exp_f32 v39, v39
  v_exp_f32 v40, v40
  v_exp_f32 v41, v41
  v_exp_f32 v42, v42
  v_exp_f32 v43, v43
  v_exp_f32 v44, v44
  v_exp_f32 v45, v45
  v_exp_f32 v46, v46
  v_smfmac_f32_32x32x32_bf16 v[64:79], v[96:99], v[32:39], v3
  v_exp_f32 v47, v47
  v_exp_f32 v16, v16
  v_exp_f32 v17, v17
  v_smfmac_f32_32x32x32_bf16 v[64:79], v[100:103], v[40:47], v3
  v_exp_f32 v18, v18
  v_exp_f32 v19, v19
  v_exp_f32 v20, v20
  v_mfma_f32_32x32x16_bf16 v[32:47], v[80:83], v[8:11], 0
  v_exp_f32 v21, v21
  v_exp_f32 v22, v22
  s_waitcnt lgkmcnt(0)
  ds_read_b128 v[96:99], v106 offset:13312
  ds_read_b128 v[100:103], v106 offset:13824
  v_exp_f32 v23, v23
  v_exp_f32 v24, v24
  v_exp_f32 v25, v25
  v_exp_f32 v26, v26
  v_exp_f32 v27, v27
  v_exp_f32 v28, v28
  v_exp_f32 v29, v29
  v_exp_f32 v30, v30
  v_smfmac_f32_32x32x32_bf16 v[48:63], v[88:91], v[16:23], v3
  v_exp_f32 v31, v31
  v_exp_f32 v32, v32
  v_exp_f32 v33, v33
  v_smfmac_f32_32x32x32_bf16 v[48:63], v[92:95], v[24:31], v3
  v_exp_f32 v34, v34
  v_exp_f32 v35, v35
  v_exp_f32 v36, v36
  v_mfma_f32_32x32x16_bf16 v[16:31], v[84:87], v[4:7], 0
  v_exp_f32 v37, v37
  v_exp_f32 v38, v38
  ds_read_b128 v[80:83], v104 offset:6144
  v_exp_f32 v39, v39
  v_exp_f32 v40, v40
  v_exp_f32 v41, v41
  v_exp_f32 v42, v42
  v_exp_f32 v43, v43
  v_exp_f32 v44, v44
  v_exp_f32 v45, v45
  v_exp_f32 v46, v46
  v_smfmac_f32_32x32x32_bf16 v[64:79], v[88:91], v[32:39], v3
  v_exp_f32 v47, v47
  v_exp_f32 v16, v16
  v_exp_f32 v17, v17
  v_smfmac_f32_32x32x32_bf16 v[64:79], v[92:95], v[40:47], v3
  v_exp_f32 v18, v18
  v_exp_f32 v19, v19
  v_exp_f32 v20, v20
  v_mfma_f32_32x32x16_bf16 v[32:47], v[84:87], v[8:11], 0
  v_exp_f32 v21, v21
  v_exp_f32 v22, v22
  s_waitcnt lgkmcnt(0)
  ds_read_b128 v[88:91], v106 offset:14336
  ds_read_b128 v[92:95], v106 offset:14848
  v_exp_f32 v23, v23
  v_exp_f32 v24, v24
  v_exp_f32 v25, v25
  s_waitcnt vmcnt(0)
  s_barrier
  s_cmp_lt_u32 s33, 3
  s_cbranch_scc1 .Lnodma
  s_and_b32 s34, s30, 0xffff
  s_mov_b32 m0, s34
  s_nop 0
  buffer_load_dwordx4 v12, s[24:27], s30 offen offset:0 sc1 lds
  buffer_load_dwordx4 v12, s[24:27], s30 offen offset:1024 sc1 lds
  buffer_load_dwordx4 v12, s[24:27], s30 offen offset:2048 sc1 lds
  buffer_load_dwordx4 v12, s[24:27], s30 offen offset:3072 sc1 lds
  s_add_u32 s30, s30, 16384
.Lnodma:
  v_exp_f32 v26, v26
  v_exp_f32 v27, v27
  v_exp_f32 v28, v28
  v_exp_f32 v29, v29
  v_exp_f32 v30, v30
  v_smfmac_f32_32x32x32_bf16 v[48:63], v[96:99], v[16:23], v3
  v_exp_f32 v31, v31
  v_exp_f32 v32, v32
  v_exp_f32 v33, v33
  v_smfmac_f32_32x32x32_bf16 v[48:63], v[100:103], v[24:31], v3
  v_exp_f32 v34, v34
  v_exp_f32 v35, v35
  v_exp_f32 v36, v36
  v_mfma_f32_32x32x16_bf16 v[16:31], v[80:83], v[4:7], 0
  v_exp_f32 v37, v37
  v_exp_f32 v38, v38
  ds_read_b128 v[84:87], v104 offset:7168
  v_exp_f32 v39, v39
  v_exp_f32 v40, v40
  v_exp_f32 v41, v41
  v_exp_f32 v42, v42
  v_exp_f32 v43, v43
  v_exp_f32 v44, v44
  v_exp_f32 v45, v45
  v_exp_f32 v46, v46
  v_smfmac_f32_32x32x32_bf16 v[64:79], v[96:99], v[32:39], v3
  v_exp_f32 v47, v47
  v_exp_f32 v16, v16
  v_exp_f32 v17, v17
  v_smfmac_f32_32x32x32_bf16 v[64:79], v[100:103], v[40:47], v3
  v_exp_f32 v18, v18
  v_exp_f32 v19, v19
  v_exp_f32 v20, v20
  v_mfma_f32_32x32x16_bf16 v[32:47], v[80:83], v[8:11], 0
  v_exp_f32 v21, v21
  v_exp_f32 v22, v22
  s_waitcnt lgkmcnt(0)
  ds_read_b128 v[96:99], v106 offset:15360
  ds_read_b128 v[100:103], v106 offset:15872
  v_exp_f32 v23, v23
  v_exp_f32 v24, v24
  v_exp_f32 v25, v25
  v_exp_f32 v26, v26
  v_exp_f32 v27, v27
  v_exp_f32 v28, v28
  v_exp_f32 v29, v29
  v_exp_f32 v30, v30
  v_smfmac_f32_32x32x32_bf16 v[48:63], v[88:91], v[16:23], v3
  v_exp_f32 v31, v31
  v_exp_f32 v32, v32
  v_exp_f32 v33, v33
  v_smfmac_f32_32x32x32_bf16 v[48:63], v[92:95], v[24:31], v3
  v_exp_f32 v34, v34
  v_exp_f32 v35, v35
  v_exp_f32 v36, v36
  v_mfma_f32_32x32x16_bf16 v[16:31], v[84:87], v[4:7], 0
  v_exp_f32 v37, v37
  v_exp_f32 v38, v38
  ds_read_b128 v[80:83], v105 offset:0
  v_exp_f32 v39, v39
  v_exp_f32 v40, v40
  v_exp_f32 v41, v41
  v_exp_f32 v42, v42
  v_exp_f32 v43, v43
  v_exp_f32 v44, v44
  v_exp_f32 v45, v45
  v_exp_f32 v46, v46
  v_smfmac_f32_32x32x32_bf16 v[64:79], v[88:91], v[32:39], v3
  v_exp_f32 v47, v47
  v_exp_f32 v16, v16
  v_exp_f32 v17, v17
  v_smfmac_f32_32x32x32_bf16 v[64:79], v[92:95], v[40:47], v3
  v_exp_f32 v18, v18
  v_exp_f32 v19, v19
  v_exp_f32 v20, v20
  v_mfma_f32_32x32x16_bf16 v[32:47], v[84:87], v[8:11], 0
  v_exp_f32 v21, v21
  v_exp_f32 v22, v22
  s_waitcnt lgkmcnt(0)
  ds_read_b128 v[88:91], v107 offset:8192
  ds_read_b128 v[92:95], v107 offset:8704
  v_exp_f32 v23, v23
  v_exp_f32 v24, v24
  v_exp_f32 v25, v25
  v_exp_f32 v26, v26
  v_exp_f32 v27, v27
  v_exp_f32 v28, v28
  v_exp_f32 v29, v29
  v_exp_f32 v30, v30
  v_smfmac_f32_32x32x32_bf16 v[48:63], v[96:99], v[16:23], v3
  v_exp_f32 v31, v31
  v_exp_f32 v32, v32
  v_exp_f32 v33, v33
  v_smfmac_f32_32x32x32_bf16 v[48:63], v[100:103], v[24:31], v3
  v_exp_f32 v34, v34
  v_exp_f32 v35, v35
  v_exp_f32 v36, v36
  v_mfma_f32_32x32x16_bf16 v[16:31], v[80:83], v[4:7], 0
  v_exp_f32 v37, v37
  v_exp_f32 v38, v38
  ds_read_b128 v[84:87], v105 offset:1024
  v_exp_f32 v39, v39
  v_exp_f32 v40, v40
  v_exp_f32 v41, v41
  v_exp_f32 v42, v42
  v_exp_f32 v43, v43
  v_exp_f32 v44, v44
  v_exp_f32 v45, v45
  v_exp_f32 v46, v46
  v_smfmac_f32_32x32x32_bf16 v[64:79], v[96:99], v[32:39], v3
  v_exp_f32 v47, v47
  v_exp_f32 v16, v16
  v_exp_f32 v17, v17
  v_smfmac_f32_32x32x32_bf16 v[64:79], v[100:103], v[40:47], v3
  v_exp_f32 v18, v18
  v_exp_f32 v19, v19
  v_exp_f32 v20, v20
  v_mfma_f32_32x32x16_bf16 v[32:47], v[80:83], v[8:11], 0
  s_add_u32 s31, s31, 16384
  s_and_b32 s31, s31, 0xffff
  v_mov_b32 v104, v105
  v_mov_b32 v106, v107
  v_add_u32 v105, s31, v12
  v_mad_u32_u24 v107, v14, s31, v13
  s_sub_u32 s33, s33, 1
  s_cmp_lg_u32 s33, 0
  s_cbranch_scc1 .Lrecurr_aloop13
  s_waitcnt lgkmcnt(0)
  s_setprio 3
  s_mov_b32 s36, 0x21800000
  s_mov_b32 s37, 0x5d800000
  s_mov_b32 s38, 0x7b800000
  v_max3_f32 v16, abs(v48), abs(v49), abs(v50)
  v_max3_f32 v16, v16, abs(v51), abs(v52)
  v_max3_f32 v16, v16, abs(v53), abs(v54)
  v_max_f32_e64 v16, v16, abs(v55)
  v_max3_f32 v17, abs(v64), abs(v65), abs(v66)
  v_max3_f32 v17, v17, abs(v67), abs(v68)
  v_max3_f32 v17, v17, abs(v69), abs(v70)
  v_max_f32_e64 v17, v17, abs(v71)
  v_add_f32 v20, v48, v50
  v_add_f32 v21, v49, v51
  v_add_f32 v22, v52, v54
  v_add_f32 v23, v53, v55
  v_add_f32 v24, v64, v66
  v_add_f32 v25, v65, v67
  v_add_f32 v26, v68, v70
  v_add_f32 v27, v69, v71
  v_add_f32 v20, v20, v22
  v_add_f32 v21, v21, v23
  v_add_f32 v24, v24, v26
  v_add_f32 v25, v25, v27
  v_add_f32 v20, v20, v24
  v_add_f32 v21, v21, v25
  v_max_f32 v16, v16, v17
  v_min_f32 v18, v56, v72
  v_max_f32 v19, v56, v72
  v_cmp_o_f32 s[46:47], v56, v72
  v_cmp_ge_f32 s[40:41], v18, s36
  v_cmp_le_f32 s[42:43], v19, s37
  v_cmp_le_f32 s[44:45], v16, s38
  v_cmp_o_f32 vcc, v20, v21
  s_and_b64 s[40:41], s[40:41], s[42:43]
  s_and_b64 s[44:45], s[44:45], s[46:47]
  s_and_b64 s[40:41], s[40:41], vcc
  s_and_b64 s[40:41], s[40:41], s[44:45]
  s_cmp_eq_u64 s[40:41], -1
  s_cbranch_scc0 .Lrecurr_aslow15
.Lrecurr_afin14:
  s_add_u32 s28, s17, 0xc00000
  s_add_u32 s29, s28, 32768
  v_rcp_f32 v16, v56
  v_rcp_f32 v18, v72
  s_nop 0
  v_mov_b32 v17, v16
  v_mov_b32 v19, v18
  v_mul_f32 v48, v48, v16
  v_mul_f32 v49, v49, v17
  v_mul_f32 v50, v50, v16
  v_mul_f32 v51, v51, v17
  v_mul_f32 v52, v52, v16
  v_mul_f32 v53, v53, v17
  v_mul_f32 v54, v54, v16
  v_mul_f32 v55, v55, v17
  v_cvt_pk_bf16_f32 v20, v48, v49
  v_cvt_pk_bf16_f32 v21, v50, v51
  v_cvt_pk_bf16_f32 v22, v52, v53
  v_cvt_pk_bf16_f32 v23, v54, v55
  buffer_store_dwordx4 v[20:23], v12, s[20:23], s28 offen sc1
  v_mul_f32 v64, v64, v18
  v_mul_f32 v65, v65, v19
  v_mul_f32 v66, v66, v18
  v_mul_f32 v67, v67, v19
  v_mul_f32 v68, v68, v18
  v_mul_f32 v69, v69, v19
  v_mul_f32 v70, v70, v18
  v_mul_f32 v71, v71, v19
  v_cvt_pk_bf16_f32 v24, v64, v65
  v_cvt_pk_bf16_f32 v25, v66, v67
  v_cvt_pk_bf16_f32 v26, v68, v69
  v_cvt_pk_bf16_f32 v27, v70, v71
  buffer_store_dwordx4 v[24:27], v12, s[20:23], s29 offen sc1
  s_lshl_b32 s30, s14, 12
  s_lshl_b32 s31, s15, 9
  s_add_u32 s30, s30, s31
  s_lshl_b32 s31, s16, 7
  s_add_u32 s30, s30, s31
  s_add_u32 s30, s30, 0xe40000
  v_mov_b32 v30, s58
  v_mov_b32 v31, s59
  v_lshlrev_b32 v32, 3, v2
  s_waitcnt vmcnt(0)
  s_mov_b64 exec, 65535
  buffer_store_dwordx2 v[30:31], v32, s[20:23], s30 offen sc1
  s_mov_b64 exec, -1
  s_lshl_b32 s40, s3, 2
  s_add_u32 s40, s40, s16
  s_cmp_lg_u32 s40, 0
  s_cbranch_scc1 .Lrecurr_ne16
  v_lshlrev_b32 v40, 3, v2
  s_mov_b32 s40, 0xe70000
  s_mov_b32 s41, 0xe70200
  s_mov_b32 s42, 0xe70400
  s_mov_b32 s43, 0xe70600
  s_mov_b32 s60, 0x40000
.Lrecurr_poll17:
  buffer_load_dwordx2 v[42:43], v40, s[20:23], s40 offen sc1
  buffer_load_dwordx2 v[44:45], v40, s[20:23], s41 offen sc1
  buffer_load_dwordx2 v[46:47], v40, s[20:23], s42 offen sc1
  buffer_load_dwordx2 v[48:49], v40, s[20:23], s43 offen sc1
  s_waitcnt vmcnt(0)
  v_cmp_eq_u64 vcc, s[58:59], v[42:43]
  v_cmp_eq_u64 s[62:63], s[58:59], v[44:45]
  s_and_b64 vcc, vcc, s[62:63]
  v_cmp_eq_u64 s[62:63], s[58:59], v[46:47]
  s_and_b64 vcc, vcc, s[62:63]
  v_cmp_eq_u64 s[62:63], s[58:59], v[48:49]
  s_and_b64 vcc, vcc, s[62:63]
  s_cmp_eq_u64 vcc, -1
  s_cbranch_scc1 .Lrecurr_polld18
  s_sleep 8
  s_sub_u32 s60, s60, 1
  s_cmp_lg_u32 s60, 0
  s_cbranch_scc1 .Lrecurr_poll17
.Lrecurr_polld18:
  s_mov_b32 s40, 0xe60000
  v_mov_b32 v110, s58
  v_mov_b32 v111, s59
  v_lshlrev_b32 v112, 3, v2
  s_mov_b64 exec, 1
  buffer_store_dwordx2 v[110:111], v112, s[20:23], s40 offen sc1
  s_mov_b64 exec, -1
.Lrecurr_ne16:
  s_endpgm
.Lrecurr_aslow15:
  s_waitcnt vmcnt(0)
  v_and_b32 v13, 15, v2
  v_lshlrev_b32 v13, 4, v13
  v_lshrrev_b32 v15, 5, v2
  v_lshl_add_u32 v13, v15, 8, v13
  v_add_u32 v13, 8192, v13
  v_cmp_eq_u32 s[54:55], 0, v14
  v_mov_b32 v108, 0x3f803f80
  v_mov_b32 v110, 0xff800000
  v_mov_b32 v111, 0xff800000
  v_mov_b32 v48, 0
  v_mov_b32 v64, 0
  v_mov_b32 v49, 0
  v_mov_b32 v65, 0
  v_mov_b32 v50, 0
  v_mov_b32 v66, 0
  v_mov_b32 v51, 0
  v_mov_b32 v67, 0
  v_mov_b32 v52, 0
  v_mov_b32 v68, 0
  v_mov_b32 v53, 0
  v_mov_b32 v69, 0
  v_mov_b32 v54, 0
  v_mov_b32 v70, 0
  v_mov_b32 v55, 0
  v_mov_b32 v71, 0
  v_mov_b32 v56, 0
  v_mov_b32 v72, 0
  v_mov_b32 v57, 0
  v_mov_b32 v73, 0
  v_mov_b32 v58, 0
  v_mov_b32 v74, 0
  v_mov_b32 v59, 0
  v_mov_b32 v75, 0
  v_mov_b32 v60, 0
  v_mov_b32 v76, 0
  v_mov_b32 v61, 0
  v_mov_b32 v77, 0
  v_mov_b32 v62, 0
  v_mov_b32 v78, 0
  v_mov_b32 v63, 0
  v_mov_b32 v79, 0
  s_mov_b32 s33, 0
.Lrecurr_asl19:
  s_lshr_b32 s34, s33, 3
  s_lshl_b32 s34, s34, 14
  s_and_b32 s35, s33, 7
  s_lshl_b32 s35, s35, 10
  s_add_u32 s34, s34, s35
  buffer_load_dwordx4 v[80:83], v12, s[24:27], s34 offen sc1
  buffer_load_dwordx4 v[88:91], v13, s[24:27], s34 offen sc1
  buffer_load_dwordx4 v[92:95], v13, s[24:27], s34 offen offset:512 sc1
  s_waitcnt vmcnt(0)
  v_cndmask_b32 v88, v88, v108, s[54:55]
  v_cndmask_b32 v89, v89, v108, s[54:55]
  v_cndmask_b32 v90, v90, v108, s[54:55]
  v_cndmask_b32 v91, v91, v108, s[54:55]
  v_cndmask_b32 v92, v92, v108, s[54:55]
  v_cndmask_b32 v93, v93, v108, s[54:55]
  v_cndmask_b32 v94, v94, v108, s[54:55]
  v_cndmask_b32 v95, v95, v108, s[54:55]
  v_mfma_f32_32x32x16_bf16 v[16:31], v[80:83], v[4:7], 0
  s_nop 11
  v_max3_f32 v112, v16, v17, v18
  v_max3_f32 v112, v112, v19, v20
  v_max3_f32 v112, v112, v21, v22
  v_max3_f32 v112, v112, v23, v24
  v_max3_f32 v112, v112, v25, v26
  v_max3_f32 v112, v112, v27, v28
  v_max3_f32 v112, v112, v29, v30
  v_max_f32 v112, v112, v31
  v_mov_b32 v113, v112
  s_nop 1
  v_permlane32_swap_b32 v112, v113
  s_nop 1
  v_max3_f32 v112, v112, v113, v110
  v_cmp_eq_f32 vcc, v110, v112
  v_sub_f32 v113, v110, v112
  v_exp_f32 v113, v113
  s_nop 0
  v_cndmask_b32 v113, v113, 1.0, vcc
  v_mov_b32 v110, v112
  v_cmp_eq_f32 vcc, 0xff800000, v112
  s_nop 1
  v_cndmask_b32 v112, v112, 0, vcc
  v_mul_f32 v48, v113, v48
  v_mul_f32 v49, v113, v49
  v_mul_f32 v50, v113, v50
  v_mul_f32 v51, v113, v51
  v_mul_f32 v52, v113, v52
  v_mul_f32 v53, v113, v53
  v_mul_f32 v54, v113, v54
  v_mul_f32 v55, v113, v55
  v_mul_f32 v56, v113, v56
  v_mul_f32 v57, v113, v57
  v_mul_f32 v58, v113, v58
  v_mul_f32 v59, v113, v59
  v_mul_f32 v60, v113, v60
  v_mul_f32 v61, v113, v61
  v_mul_f32 v62, v113, v62
  v_mul_f32 v63, v113, v63
  v_sub_f32 v16, v16, v112
  v_sub_f32 v17, v17, v112
  v_sub_f32 v18, v18, v112
  v_sub_f32 v19, v19, v112
  v_sub_f32 v20, v20, v112
  v_sub_f32 v21, v21, v112
  v_sub_f32 v22, v22, v112
  v_sub_f32 v23, v23, v112
  v_sub_f32 v24, v24, v112
  v_sub_f32 v25, v25, v112
  v_sub_f32 v26, v26, v112
  v_sub_f32 v27, v27, v112
  v_sub_f32 v28, v28, v112
  v_sub_f32 v29, v29, v112
  v_sub_f32 v30, v30, v112
  v_sub_f32 v31, v31, v112
  v_exp_f32 v16, v16
  v_exp_f32 v17, v17
  v_exp_f32 v18, v18
  v_exp_f32 v19, v19
  v_exp_f32 v20, v20
  v_exp_f32 v21, v21
  v_exp_f32 v22, v22
  v_exp_f32 v23, v23
  v_exp_f32 v24, v24
  v_exp_f32 v25, v25
  v_exp_f32 v26, v26
  v_exp_f32 v27, v27
  v_exp_f32 v28, v28
  v_exp_f32 v29, v29
  v_exp_f32 v30, v30
  v_exp_f32 v31, v31
  s_nop 1
  v_smfmac_f32_32x32x32_bf16 v[48:63], v[88:91], v[16:23], v3
  v_smfmac_f32_32x32x32_bf16 v[48:63], v[92:95], v[24:31], v3
  v_mfma_f32_32x32x16_bf16 v[32:47], v[80:83], v[8:11], 0
  s_nop 11
  v_max3_f32 v112, v32, v33, v34
  v_max3_f32 v112, v112, v35, v36
  v_max3_f32 v112, v112, v37, v38
  v_max3_f32 v112, v112, v39, v40
  v_max3_f32 v112, v112, v41, v42
  v_max3_f32 v112, v112, v43, v44
  v_max3_f32 v112, v112, v45, v46
  v_max_f32 v112, v112, v47
  v_mov_b32 v113, v112
  s_nop 1
  v_permlane32_swap_b32 v112, v113
  s_nop 1
  v_max3_f32 v112, v112, v113, v111
  v_cmp_eq_f32 vcc, v111, v112
  v_sub_f32 v113, v111, v112
  v_exp_f32 v113, v113
  s_nop 0
  v_cndmask_b32 v113, v113, 1.0, vcc
  v_mov_b32 v111, v112
  v_cmp_eq_f32 vcc, 0xff800000, v112
  s_nop 1
  v_cndmask_b32 v112, v112, 0, vcc
  v_mul_f32 v64, v113, v64
  v_mul_f32 v65, v113, v65
  v_mul_f32 v66, v113, v66
  v_mul_f32 v67, v113, v67
  v_mul_f32 v68, v113, v68
  v_mul_f32 v69, v113, v69
  v_mul_f32 v70, v113, v70
  v_mul_f32 v71, v113, v71
  v_mul_f32 v72, v113, v72
  v_mul_f32 v73, v113, v73
  v_mul_f32 v74, v113, v74
  v_mul_f32 v75, v113, v75
  v_mul_f32 v76, v113, v76
  v_mul_f32 v77, v113, v77
  v_mul_f32 v78, v113, v78
  v_mul_f32 v79, v113, v79
  v_sub_f32 v32, v32, v112
  v_sub_f32 v33, v33, v112
  v_sub_f32 v34, v34, v112
  v_sub_f32 v35, v35, v112
  v_sub_f32 v36, v36, v112
  v_sub_f32 v37, v37, v112
  v_sub_f32 v38, v38, v112
  v_sub_f32 v39, v39, v112
  v_sub_f32 v40, v40, v112
  v_sub_f32 v41, v41, v112
  v_sub_f32 v42, v42, v112
  v_sub_f32 v43, v43, v112
  v_sub_f32 v44, v44, v112
  v_sub_f32 v45, v45, v112
  v_sub_f32 v46, v46, v112
  v_sub_f32 v47, v47, v112
  v_exp_f32 v32, v32
  v_exp_f32 v33, v33
  v_exp_f32 v34, v34
  v_exp_f32 v35, v35
  v_exp_f32 v36, v36
  v_exp_f32 v37, v37
  v_exp_f32 v38, v38
  v_exp_f32 v39, v39
  v_exp_f32 v40, v40
  v_exp_f32 v41, v41
  v_exp_f32 v42, v42
  v_exp_f32 v43, v43
  v_exp_f32 v44, v44
  v_exp_f32 v45, v45
  v_exp_f32 v46, v46
  v_exp_f32 v47, v47
  s_nop 1
  v_smfmac_f32_32x32x32_bf16 v[64:79], v[88:91], v[32:39], v3
  v_smfmac_f32_32x32x32_bf16 v[64:79], v[92:95], v[40:47], v3
  s_nop 11
  s_add_u32 s33, s33, 1
  s_cmp_lt_u32 s33, 64
  s_cbranch_scc1 .Lrecurr_asl19
  s_branch .Lrecurr_afin14
.Lrecurr_roleg2:
  s_setprio 2
  s_load_dwordx4 s[4:7], s[0:1], 48
  s_load_dwordx2 s[12:13], s[0:1], 88
  s_load_dwordx2 s[8:9], s[0:1], 0
  s_load_dwordx4 s[52:55], s[0:1], 64
  s_load_dwordx2 s[10:11], s[0:1], 32
  v_lshrrev_b32 v1, 6, v0
  v_and_b32 v2, 63, v0
  v_readfirstlane_b32 s16, v1
  v_lshlrev_b32 v3, 4, v2
  s_and_b32 s14, s3, 3
  s_lshl_b32 s14, s14, 2
  s_bfe_u32 s15, s3, 0x20003
  s_add_u32 s14, s14, s15
  s_bfe_u32 s15, s3, 0x10002
  s_mul_i32 s15, s15, 7
  s_lshr_b32 s17, s3, 5
  s_add_u32 s15, s15, s17
  s_and_b32 s18, s16, 1
  s_lshr_b32 s19, s16, 1
  v_lshrrev_b32 v16, 4, v2
  v_lshl_add_u32 v17, v16, 1, s18
  v_bfe_u32 v18, v2, 1, 3
  v_xor_b32 v17, v17, v18
  v_lshlrev_b32 v17, 5, v17
  v_and_b32 v18, 1, v2
  v_lshl_add_u32 v17, v18, 4, v17
  v_mul_u32_u24 v16, 3584, v16
  v_add_u32 v4, v16, v17
  v_add_u32 v5, 13312, v4
  v_add_u32 v6, 26624, v4
  v_add_u32 v7, 39936, v4
  v_lshrrev_b32 v16, 2, v2
  v_lshrrev_b32 v17, 4, v2
  v_and_b32 v18, 3, v2
  v_xor_b32 v17, v17, v18
  v_lshlrev_b32 v17, 4, v17
  v_lshl_add_u32 v8, v16, 10, v17
  v_add_u32 v9, 15360, v8
  s_mul_i32 s20, s19, 57344
  s_lshl_b32 s21, s15, 8
  s_add_u32 s20, s20, s21
  s_lshl_b32 s21, s18, 13
  s_lshl_b32 s22, s19, 12
  s_add_u32 s21, s21, s22
  s_lshl_b32 s22, s16, 11
  s_add_u32 s22, s22, 16384
  s_lshl_b32 s34, s14, 17
  s_lshl_b32 s23, s16, 15
  s_add_u32 s34, s34, s23
  s_cmp_eq_u32 s18, 1
  s_waitcnt lgkmcnt(0)
  s_cselect_b32 s24, s6, s4
  s_cselect_b32 s25, s7, s5
  s_mov_b32 s26, 1835008
  s_mov_b32 s27, 0x20000
  s_mov_b32 s36, s8
  s_mov_b32 s37, s9
  s_mov_b32 s38, 0x200000
  s_mov_b32 s39, 0x20000
  s_mov_b32 s28, s12
  s_mov_b32 s29, s13
  s_mov_b32 s30, 0x1000000
  s_mov_b32 s31, 0x20000
  v_mov_b32 v79, 0
  v_mov_b32 v94, 0
  s_mov_b32 s56, 0xe60000
  buffer_load_dwordx2 v[92:93], v94, s[28:31], s56 offen
  s_cmp_ge_u32 s3, 224
  s_cbranch_scc1 .Lrecurr_noup20
  s_add_u32 m0, s22, 0
  s_nop 0
  buffer_load_dwordx4 v8, s[36:39], s34 offen offset:0 lds
  buffer_load_dwordx4 v9, s[36:39], s34 offen offset:1024 lds
  s_add_u32 m0, s21, 0
  s_add_u32 s34, s34, 64
  buffer_load_dwordx4 v4, s[24:27], s20 offen offset:0 lds
  buffer_load_dwordx4 v5, s[24:27], s20 offen offset:1024 lds
  buffer_load_dwordx4 v6, s[24:27], s20 offen offset:2048 lds
  buffer_load_dwordx4 v7, s[24:27], s20 offen offset:3072 lds
  s_add_u32 s20, s20, 114688
  s_add_u32 m0, s22, 24576
  s_nop 0
  buffer_load_dwordx4 v8, s[36:39], s34 offen offset:0 lds
  buffer_load_dwordx4 v9, s[36:39], s34 offen offset:1024 lds
  s_add_u32 m0, s21, 24576
  s_add_u32 s34, s34, 64
  buffer_load_dwordx4 v4, s[24:27], s20 offen offset:0 lds
  buffer_load_dwordx4 v5, s[24:27], s20 offen offset:1024 lds
  buffer_load_dwordx4 v6, s[24:27], s20 offen offset:2048 lds
  buffer_load_dwordx4 v7, s[24:27], s20 offen offset:3072 lds
  s_add_u32 s20, s20, 114688
  s_add_u32 m0, s22, 49152
  s_nop 0
  buffer_load_dwordx4 v8, s[36:39], s34 offen offset:0 lds
  buffer_load_dwordx4 v9, s[36:39], s34 offen offset:1024 lds
  s_add_u32 m0, s21, 49152
  s_add_u32 s34, s34, 64
  buffer_load_dwordx4 v4, s[24:27], s20 offen offset:0 lds
  buffer_load_dwordx4 v5, s[24:27], s20 offen offset:1024 lds
  buffer_load_dwordx4 v6, s[24:27], s20 offen offset:2048 lds
  buffer_load_dwordx4 v7, s[24:27], s20 offen offset:3072 lds
  s_add_u32 s20, s20, 114688
  v_lshrrev_b32 v16, 5, v2
  v_bfe_u32 v17, v2, 2, 2
  v_bfe_u32 v18, v2, 4, 1
  v_lshl_add_u32 v19, v16, 3, v17
  v_lshlrev_b32 v19, 8, v19
  v_lshl_add_u32 v19, v18, 13, v19
  v_and_b32 v20, 3, v2
  v_lshl_add_u32 v19, v20, 3, v19
  v_lshl_add_u32 v17, v17, 1, v18
  s_lshl_b32 s47, s19, 2
  v_xor_b32 v17, s47, v17
  v_xor_b32 v20, 0, v17
  v_lshl_add_u32 v64, v20, 5, v19
  v_xor_b32 v20, 1, v17
  v_lshl_add_u32 v65, v20, 5, v19
  v_xor_b32 v20, 2, v17
  v_lshl_add_u32 v66, v20, 5, v19
  v_xor_b32 v20, 3, v17
  v_lshl_add_u32 v67, v20, 5, v19
  v_and_b32 v17, 31, v2
  v_lshlrev_b32 v77, 4, v17
  v_bfe_u32 v18, v2, 2, 2
  v_xor_b32 v18, v18, v16
  v_lshlrev_b32 v18, 4, v18
  v_lshl_add_u32 v18, v17, 6, v18
  s_lshl_b32 s47, s18, 12
  s_add_u32 s47, s47, 16384
  v_add_u32 v68, s47, v18
  v_xor_b32 v69, 32, v68
  v_lshrrev_b32 v18, 4, v2
  v_lshrrev_b32 v19, 2, v2
  v_xor_b32 v18, v18, v19
  v_and_b32 v18, 1, v18
  v_cmp_eq_u32 vcc, 0, v18
  v_mov_b32 v18, 0x3f803f80
  s_nop 0
  v_cndmask_b32 v72, 0, v18, vcc
  v_cndmask_b32 v73, 0, v18, vcc
  v_cndmask_b32 v74, 0, v18, vcc
  v_cndmask_b32 v75, 0, v18, vcc
  v_mov_b32 v112, 0
  v_mov_b32 v113, 0
  v_mov_b32 v114, 0
  v_mov_b32 v115, 0
  v_mov_b32 v116, 0
  v_mov_b32 v117, 0
  v_mov_b32 v118, 0
  v_mov_b32 v119, 0
  v_mov_b32 v120, 0
  v_mov_b32 v121, 0
  v_mov_b32 v122, 0
  v_mov_b32 v123, 0
  v_mov_b32 v124, 0
  v_mov_b32 v125, 0
  v_mov_b32 v126, 0
  v_mov_b32 v127, 0
  s_lshl_b32 s44, s14, 1
  s_add_u32 s44, s44, s18
  s_lshl_b32 s45, s44, 10
  s_add_u32 s45, s45, 0xe80000
  s_add_u32 s46, s45, 32768
  v_mov_b32 v128, 0
  v_mov_b32 v129, 0
  v_mov_b32 v130, 0
  v_mov_b32 v131, 0
  v_mov_b32 v132, 0
  v_mov_b32 v133, 0
  v_mov_b32 v134, 0
  v_mov_b32 v135, 0
  v_mov_b32 v136, 0
  v_mov_b32 v137, 0
  v_mov_b32 v138, 0
  v_mov_b32 v139, 0
  v_mov_b32 v140, 0
  v_mov_b32 v141, 0
  v_mov_b32 v142, 0
  v_mov_b32 v143, 0
  v_mov_b32 v144, 0
  v_mov_b32 v145, 0
  v_mov_b32 v146, 0
  v_mov_b32 v147, 0
  v_mov_b32 v148, 0
  v_mov_b32 v149, 0
  v_mov_b32 v150, 0
  v_mov_b32 v151, 0
  v_mov_b32 v152, 0
  v_mov_b32 v153, 0
  v_mov_b32 v154, 0
  v_mov_b32 v155, 0
  v_mov_b32 v156, 0
  v_mov_b32 v157, 0
  v_mov_b32 v158, 0
  v_mov_b32 v159, 0
  v_mov_b32 v160, 0
  v_mov_b32 v161, 0
  v_mov_b32 v162, 0
  v_mov_b32 v163, 0
  v_mov_b32 v164, 0
  v_mov_b32 v165, 0
  v_mov_b32 v166, 0
  v_mov_b32 v167, 0
  v_mov_b32 v168, 0
  v_mov_b32 v169, 0
  v_mov_b32 v170, 0
  v_mov_b32 v171, 0
  v_mov_b32 v172, 0
  v_mov_b32 v173, 0
  v_mov_b32 v174, 0
  v_mov_b32 v175, 0
  v_mov_b32 v176, 0
  v_mov_b32 v177, 0
  v_mov_b32 v178, 0
  v_mov_b32 v179, 0
  v_mov_b32 v180, 0
  v_mov_b32 v181, 0
  v_mov_b32 v182, 0
  v_mov_b32 v183, 0
  v_mov_b32 v184, 0
  v_mov_b32 v185, 0
  v_mov_b32 v186, 0
  v_mov_b32 v187, 0
  v_mov_b32 v188, 0
  v_mov_b32 v189, 0
  v_mov_b32 v190, 0
  v_mov_b32 v191, 0
  v_mov_b32 v192, 0
  v_mov_b32 v193, 0
  v_mov_b32 v194, 0
  v_mov_b32 v195, 0
  v_mov_b32 v196, 0
  v_mov_b32 v197, 0
  v_mov_b32 v198, 0
  v_mov_b32 v199, 0
  v_mov_b32 v200, 0
  v_mov_b32 v201, 0
  v_mov_b32 v202, 0
  v_mov_b32 v203, 0
  v_mov_b32 v204, 0
  v_mov_b32 v205, 0
  v_mov_b32 v206, 0
  v_mov_b32 v207, 0
  v_mov_b32 v208, 0
  v_mov_b32 v209, 0
  v_mov_b32 v210, 0
  v_mov_b32 v211, 0
  v_mov_b32 v212, 0
  v_mov_b32 v213, 0
  v_mov_b32 v214, 0
  v_mov_b32 v215, 0
  v_mov_b32 v216, 0
  v_mov_b32 v217, 0
  v_mov_b32 v218, 0
  v_mov_b32 v219, 0
  v_mov_b32 v220, 0
  v_mov_b32 v221, 0
  v_mov_b32 v222, 0
  v_mov_b32 v223, 0
  v_mov_b32 v224, 0
  v_mov_b32 v225, 0
  v_mov_b32 v226, 0
  v_mov_b32 v227, 0
  v_mov_b32 v228, 0
  v_mov_b32 v229, 0
  v_mov_b32 v230, 0
  v_mov_b32 v231, 0
  v_mov_b32 v232, 0
  v_mov_b32 v233, 0
  v_mov_b32 v234, 0
  v_mov_b32 v235, 0
  v_mov_b32 v236, 0
  v_mov_b32 v237, 0
  v_mov_b32 v238, 0
  v_mov_b32 v239, 0
  v_mov_b32 v240, 0
  v_mov_b32 v241, 0
  v_mov_b32 v242, 0
  v_mov_b32 v243, 0
  v_mov_b32 v244, 0
  v_mov_b32 v245, 0
  v_mov_b32 v246, 0
  v_mov_b32 v247, 0
  v_mov_b32 v248, 0
  v_mov_b32 v249, 0
  v_mov_b32 v250, 0
  v_mov_b32 v251, 0
  v_mov_b32 v252, 0
  v_mov_b32 v253, 0
  v_mov_b32 v254, 0
  v_mov_b32 v255, 0
  s_mul_i32 s17, s16, 17408
  v_lshrrev_b32 v20, 3, v2
  v_and_b32 v21, 7, v2
  v_lshlrev_b32 v22, 1, v20
  v_and_b32 v22, 4, v22
  v_xor_b32 v22, v22, v21
  v_lshlrev_b32 v22, 4, v22
  v_lshl_add_u32 v104, v20, 10, v22
  v_add_u32 v105, 7168, v104
  v_add_u32 v106, 114688, v3
  v_add_u32 v107, 32768, v3
  v_lshlrev_b32 v14, 4, v21
  v_lshl_add_u32 v14, v20, 10, v14
  v_mul_u32_u24 v11, 1088, v21
  v_lshl_add_u32 v11, v20, 4, v11
  s_lshr_b32 s48, s16, 1
  s_mul_i32 s48, s48, 8704
  s_and_b32 s49, s16, 1
  s_lshl_b32 s49, s49, 8
  s_add_u32 s48, s48, s49
  v_add_u32 v11, s48, v11
  v_min_u32 v15, 6, v21
  v_lshlrev_b32 v15, 7, v15
  v_lshrrev_b32 v22, 5, v2
  v_bfe_u32 v23, v2, 2, 2
  v_lshl_add_u32 v22, v22, 2, v23
  v_lshlrev_b32 v22, 7, v22
  v_and_b32 v20, 1, v2
  v_lshl_add_u32 v22, v20, 3, v22
  v_add_u32 v22, s17, v22
  v_bfe_u32 v20, v2, 4, 1
  v_bfe_u32 v21, v2, 1, 1
  v_lshl_add_u32 v21, v20, 1, v21
  v_lshlrev_b32 v23, 1, v23
  v_and_b32 v23, 4, v23
  v_xor_b32 v21, v21, v23
  v_lshl_add_u32 v108, v21, 4, v22
  v_xor_b32 v21, 4, v21
  v_lshl_add_u32 v109, v21, 4, v22
  v_add_u32 v10, s17, v3
  v_mov_b32 v12, 0xc0135761
  v_mov_b32 v13, 0xc0135761
  s_lshl_b32 s47, s19, 10
  s_add_u32 s47, s47, 73728
  v_lshlrev_b32 v71, 2, v2
  v_add_u32 v71, s47, v71
  v_and_b32 v70, 31, v2
  v_lshlrev_b32 v70, 2, v70
  s_lshl_b32 s48, s18, 7
  s_add_u32 s48, s48, s47
  v_add_u32 v70, s48, v70
  s_waitcnt vmcnt(12)
  s_barrier
  v_readfirstlane_b32 s56, v92
  v_readfirstlane_b32 s57, v93
  s_mul_i32 s58, s56, 1664525
  s_add_u32 s58, s58, 1013904223
  s_mul_i32 s59, s57, 22695477
  s_add_u32 s59, s59, 0x3c6ef35f
  s_cmp_lg_u32 s16, 0
  s_cbranch_scc1 .Lrecurr_hl21
  s_lshl_b32 s50, s3, 3
  s_add_u32 s50, s50, 0xe70000
  v_mov_b32 v92, s58
  v_mov_b32 v93, s59
  v_lshlrev_b32 v94, 3, v2
  s_mov_b64 exec, 1
  buffer_store_dwordx2 v[92:93], v94, s[28:31], s50 offen sc1
  s_mov_b64 exec, -1
.Lrecurr_hl21:
  ds_read_b128 v[48:51], v68 offset:0
  ds_read_b128 v[52:55], v68 offset:2048
  ds_read_b64_tr_b16 v[16:17], v64 offset:0
  ds_read_b64_tr_b16 v[18:19], v64 offset:1024
  ds_read_b64_tr_b16 v[20:21], v65 offset:0
  ds_read_b64_tr_b16 v[22:23], v65 offset:1024
  ds_read_b64_tr_b16 v[24:25], v66 offset:0
  ds_read_b64_tr_b16 v[26:27], v66 offset:1024
  ds_read_b64_tr_b16 v[28:29], v67 offset:0
  ds_read_b64_tr_b16 v[30:31], v67 offset:1024
  s_setprio 0
  s_mov_b32 s48, 5
  s_cmp_eq_u32 s18, 1
  s_cbranch_scc1 .Lrecurr_th122
.Lrecurr_uloop24:
  s_waitcnt lgkmcnt(6)
  v_mfma_f32_32x32x16_bf16 v[128:143], v[16:19], v[48:51], v[128:143]
  ds_read_b128 v[56:59], v69 offset:0
  ds_read_b128 v[60:63], v69 offset:2048
  v_mfma_f32_32x32x16_bf16 v[144:159], v[16:19], v[52:55], v[144:159]
  v_mfma_f32_16x16x32_bf16 v[112:115], v[72:75], v[16:19], v[112:115]
  ds_read_b64_tr_b16 v[32:33], v64 offset:4096
  ds_read_b64_tr_b16 v[34:35], v64 offset:5120
  s_waitcnt lgkmcnt(8)
  v_mfma_f32_32x32x16_bf16 v[160:175], v[20:23], v[48:51], v[160:175]
  ds_read_b64_tr_b16 v[36:37], v65 offset:4096
  ds_read_b64_tr_b16 v[38:39], v65 offset:5120
  v_mfma_f32_32x32x16_bf16 v[176:191], v[20:23], v[52:55], v[176:191]
  v_mfma_f32_16x16x32_bf16 v[116:119], v[72:75], v[20:23], v[116:119]
  ds_read_b64_tr_b16 v[40:41], v66 offset:4096
  ds_read_b64_tr_b16 v[42:43], v66 offset:5120
  s_waitcnt lgkmcnt(10)
  v_mfma_f32_32x32x16_bf16 v[192:207], v[24:27], v[48:51], v[192:207]
  ds_read_b64_tr_b16 v[44:45], v67 offset:4096
  ds_read_b64_tr_b16 v[46:47], v67 offset:5120
  v_mfma_f32_32x32x16_bf16 v[208:223], v[24:27], v[52:55], v[208:223]
  v_mfma_f32_16x16x32_bf16 v[120:123], v[72:75], v[24:27], v[120:123]
  s_waitcnt lgkmcnt(10)
  v_mfma_f32_32x32x16_bf16 v[224:239], v[28:31], v[48:51], v[224:239]
  v_mfma_f32_32x32x16_bf16 v[240:255], v[28:31], v[52:55], v[240:255]
  v_mfma_f32_16x16x32_bf16 v[124:127], v[72:75], v[28:31], v[124:127]
  s_waitcnt lgkmcnt(6)
  v_mfma_f32_32x32x16_bf16 v[128:143], v[32:35], v[56:59], v[128:143]
  s_waitcnt vmcnt(6) lgkmcnt(0)
  s_barrier
  ds_read_b128 v[48:51], v68 offset:24576
  ds_read_b128 v[52:55], v68 offset:26624
  v_mfma_f32_32x32x16_bf16 v[144:159], v[32:35], v[60:63], v[144:159]
  ds_read_b64_tr_b16 v[16:17], v64 offset:24576
  ds_read_b64_tr_b16 v[18:19], v64 offset:25600
  v_mfma_f32_32x32x16_bf16 v[160:175], v[36:39], v[56:59], v[160:175]
  ds_read_b64_tr_b16 v[20:21], v65 offset:24576
  ds_read_b64_tr_b16 v[22:23], v65 offset:25600
  s_add_u32 m0, s22, 0
  s_nop 0
  buffer_load_dwordx4 v8, s[36:39], s34 offen offset:0 lds
  v_mfma_f32_32x32x16_bf16 v[176:191], v[36:39], v[60:63], v[176:191]
  ds_read_b64_tr_b16 v[24:25], v66 offset:24576
  ds_read_b64_tr_b16 v[26:27], v66 offset:25600
  buffer_load_dwordx4 v9, s[36:39], s34 offen offset:1024 lds
  v_mfma_f32_32x32x16_bf16 v[192:207], v[40:43], v[56:59], v[192:207]
  ds_read_b64_tr_b16 v[28:29], v67 offset:24576
  ds_read_b64_tr_b16 v[30:31], v67 offset:25600
  s_add_u32 m0, s21, 0
  s_add_u32 s34, s34, 64
  buffer_load_dwordx4 v4, s[24:27], s20 offen offset:0 lds
  v_mfma_f32_32x32x16_bf16 v[208:223], v[40:43], v[60:63], v[208:223]
  buffer_load_dwordx4 v5, s[24:27], s20 offen offset:1024 lds
  v_mfma_f32_32x32x16_bf16 v[224:239], v[44:47], v[56:59], v[224:239]
  buffer_load_dwordx4 v6, s[24:27], s20 offen offset:2048 lds
  v_mfma_f32_32x32x16_bf16 v[240:255], v[44:47], v[60:63], v[240:255]
  buffer_load_dwordx4 v7, s[24:27], s20 offen offset:3072 lds
  s_add_u32 s20, s20, 114688
  s_waitcnt lgkmcnt(6)
  v_mfma_f32_32x32x16_bf16 v[128:143], v[16:19], v[48:51], v[128:143]
  ds_read_b128 v[56:59], v69 offset:24576
  ds_read_b128 v[60:63], v69 offset:26624
  v_mfma_f32_32x32x16_bf16 v[144:159], v[16:19], v[52:55], v[144:159]
  v_mfma_f32_16x16x32_bf16 v[112:115], v[72:75], v[16:19], v[112:115]
  ds_read_b64_tr_b16 v[32:33], v64 offset:28672
  ds_read_b64_tr_b16 v[34:35], v64 offset:29696
  s_waitcnt lgkmcnt(8)
  v_mfma_f32_32x32x16_bf16 v[160:175], v[20:23], v[48:51], v[160:175]
  ds_read_b64_tr_b16 v[36:37], v65 offset:28672
  ds_read_b64_tr_b16 v[38:39], v65 offset:29696
  v_mfma_f32_32x32x16_bf16 v[176:191], v[20:23], v[52:55], v[176:191]
  v_mfma_f32_16x16x32_bf16 v[116:119], v[72:75], v[20:23], v[116:119]
  ds_read_b64_tr_b16 v[40:41], v66 offset:28672
  ds_read_b64_tr_b16 v[42:43], v66 offset:29696
  s_waitcnt lgkmcnt(10)
  v_mfma_f32_32x32x16_bf16 v[192:207], v[24:27], v[48:51], v[192:207]
  ds_read_b64_tr_b16 v[44:45], v67 offset:28672
  ds_read_b64_tr_b16 v[46:47], v67 offset:29696
  v_mfma_f32_32x32x16_bf16 v[208:223], v[24:27], v[52:55], v[208:223]
  v_mfma_f32_16x16x32_bf16 v[120:123], v[72:75], v[24:27], v[120:123]
  s_waitcnt lgkmcnt(10)
  v_mfma_f32_32x32x16_bf16 v[224:239], v[28:31], v[48:51], v[224:239]
  v_mfma_f32_32x32x16_bf16 v[240:255], v[28:31], v[52:55], v[240:255]
  v_mfma_f32_16x16x32_bf16 v[124:127], v[72:75], v[28:31], v[124:127]
  s_waitcnt lgkmcnt(6)
  v_mfma_f32_32x32x16_bf16 v[128:143], v[32:35], v[56:59], v[128:143]
  s_waitcnt vmcnt(6) lgkmcnt(0)
  s_barrier
  ds_read_b128 v[48:51], v68 offset:49152
  ds_read_b128 v[52:55], v68 offset:51200
  v_mfma_f32_32x32x16_bf16 v[144:159], v[32:35], v[60:63], v[144:159]
  ds_read_b64_tr_b16 v[16:17], v64 offset:49152
  ds_read_b64_tr_b16 v[18:19], v64 offset:50176
  v_mfma_f32_32x32x16_bf16 v[160:175], v[36:39], v[56:59], v[160:175]
  ds_read_b64_tr_b16 v[20:21], v65 offset:49152
  ds_read_b64_tr_b16 v[22:23], v65 offset:50176
  s_add_u32 m0, s22, 24576
  s_nop 0
  buffer_load_dwordx4 v8, s[36:39], s34 offen offset:0 lds
  v_mfma_f32_32x32x16_bf16 v[176:191], v[36:39], v[60:63], v[176:191]
  ds_read_b64_tr_b16 v[24:25], v66 offset:49152
  ds_read_b64_tr_b16 v[26:27], v66 offset:50176
  buffer_load_dwordx4 v9, s[36:39], s34 offen offset:1024 lds
  v_mfma_f32_32x32x16_bf16 v[192:207], v[40:43], v[56:59], v[192:207]
  ds_read_b64_tr_b16 v[28:29], v67 offset:49152
  ds_read_b64_tr_b16 v[30:31], v67 offset:50176
  s_add_u32 m0, s21, 24576
  s_add_u32 s34, s34, 64
  buffer_load_dwordx4 v4, s[24:27], s20 offen offset:0 lds
  v_mfma_f32_32x32x16_bf16 v[208:223], v[40:43], v[60:63], v[208:223]
  buffer_load_dwordx4 v5, s[24:27], s20 offen offset:1024 lds
  v_mfma_f32_32x32x16_bf16 v[224:239], v[44:47], v[56:59], v[224:239]
  buffer_load_dwordx4 v6, s[24:27], s20 offen offset:2048 lds
  v_mfma_f32_32x32x16_bf16 v[240:255], v[44:47], v[60:63], v[240:255]
  buffer_load_dwordx4 v7, s[24:27], s20 offen offset:3072 lds
  s_add_u32 s20, s20, 114688
  s_waitcnt lgkmcnt(6)
  v_mfma_f32_32x32x16_bf16 v[128:143], v[16:19], v[48:51], v[128:143]
  ds_read_b128 v[56:59], v69 offset:49152
  ds_read_b128 v[60:63], v69 offset:51200
  v_mfma_f32_32x32x16_bf16 v[144:159], v[16:19], v[52:55], v[144:159]
  v_mfma_f32_16x16x32_bf16 v[112:115], v[72:75], v[16:19], v[112:115]
  ds_read_b64_tr_b16 v[32:33], v64 offset:53248
  ds_read_b64_tr_b16 v[34:35], v64 offset:54272
  s_waitcnt lgkmcnt(8)
  v_mfma_f32_32x32x16_bf16 v[160:175], v[20:23], v[48:51], v[160:175]
  ds_read_b64_tr_b16 v[36:37], v65 offset:53248
  ds_read_b64_tr_b16 v[38:39], v65 offset:54272
  v_mfma_f32_32x32x16_bf16 v[176:191], v[20:23], v[52:55], v[176:191]
  v_mfma_f32_16x16x32_bf16 v[116:119], v[72:75], v[20:23], v[116:119]
  ds_read_b64_tr_b16 v[40:41], v66 offset:53248
  ds_read_b64_tr_b16 v[42:43], v66 offset:54272
  s_waitcnt lgkmcnt(10)
  v_mfma_f32_32x32x16_bf16 v[192:207], v[24:27], v[48:51], v[192:207]
  ds_read_b64_tr_b16 v[44:45], v67 offset:53248
  ds_read_b64_tr_b16 v[46:47], v67 offset:54272
  v_mfma_f32_32x32x16_bf16 v[208:223], v[24:27], v[52:55], v[208:223]
  v_mfma_f32_16x16x32_bf16 v[120:123], v[72:75], v[24:27], v[120:123]
  s_waitcnt lgkmcnt(10)
  v_mfma_f32_32x32x16_bf16 v[224:239], v[28:31], v[48:51], v[224:239]
  s_cmp_lg_u32 s48, 1
  s_cbranch_scc1 .Lskipst0
  buffer_load_dwordx4 v[80:83], v77, s[28:31], s45 offen sc1
  buffer_load_dwordx4 v[84:87], v77, s[28:31], s45 offen offset:512 sc1
.Lskipst0:
  v_mfma_f32_32x32x16_bf16 v[240:255], v[28:31], v[52:55], v[240:255]
  v_mfma_f32_16x16x32_bf16 v[124:127], v[72:75], v[28:31], v[124:127]
  s_waitcnt lgkmcnt(6)
  v_mfma_f32_32x32x16_bf16 v[128:143], v[32:35], v[56:59], v[128:143]
  s_waitcnt vmcnt(6) lgkmcnt(0)
  s_barrier
  ds_read_b128 v[48:51], v68 offset:0
  ds_read_b128 v[52:55], v68 offset:2048
  v_mfma_f32_32x32x16_bf16 v[144:159], v[32:35], v[60:63], v[144:159]
  ds_read_b64_tr_b16 v[16:17], v64 offset:0
  ds_read_b64_tr_b16 v[18:19], v64 offset:1024
  v_mfma_f32_32x32x16_bf16 v[160:175], v[36:39], v[56:59], v[160:175]
  ds_read_b64_tr_b16 v[20:21], v65 offset:0
  ds_read_b64_tr_b16 v[22:23], v65 offset:1024
  s_add_u32 m0, s22, 49152
  s_nop 0
  buffer_load_dwordx4 v8, s[36:39], s34 offen offset:0 lds
  v_mfma_f32_32x32x16_bf16 v[176:191], v[36:39], v[60:63], v[176:191]
  ds_read_b64_tr_b16 v[24:25], v66 offset:0
  ds_read_b64_tr_b16 v[26:27], v66 offset:1024
  buffer_load_dwordx4 v9, s[36:39], s34 offen offset:1024 lds
  v_mfma_f32_32x32x16_bf16 v[192:207], v[40:43], v[56:59], v[192:207]
  ds_read_b64_tr_b16 v[28:29], v67 offset:0
  ds_read_b64_tr_b16 v[30:31], v67 offset:1024
  s_add_u32 m0, s21, 49152
  s_add_u32 s34, s34, 64
  buffer_load_dwordx4 v4, s[24:27], s20 offen offset:0 lds
  v_mfma_f32_32x32x16_bf16 v[208:223], v[40:43], v[60:63], v[208:223]
  buffer_load_dwordx4 v5, s[24:27], s20 offen offset:1024 lds
  v_mfma_f32_32x32x16_bf16 v[224:239], v[44:47], v[56:59], v[224:239]
  buffer_load_dwordx4 v6, s[24:27], s20 offen offset:2048 lds
  v_mfma_f32_32x32x16_bf16 v[240:255], v[44:47], v[60:63], v[240:255]
  buffer_load_dwordx4 v7, s[24:27], s20 offen offset:3072 lds
  s_add_u32 s20, s20, 114688
  s_sub_u32 s48, s48, 1
  s_cmp_lg_u32 s48, 0
  s_cbranch_scc1 .Lrecurr_uloop24
  s_waitcnt lgkmcnt(6)
  v_mfma_f32_32x32x16_bf16 v[128:143], v[16:19], v[48:51], v[128:143]
  ds_read_b128 v[56:59], v69 offset:0
  ds_read_b128 v[60:63], v69 offset:2048
  v_mfma_f32_32x32x16_bf16 v[144:159], v[16:19], v[52:55], v[144:159]
  v_mfma_f32_16x16x32_bf16 v[112:115], v[72:75], v[16:19], v[112:115]
  ds_read_b64_tr_b16 v[32:33], v64 offset:4096
  ds_read_b64_tr_b16 v[34:35], v64 offset:5120
  s_waitcnt lgkmcnt(8)
  v_mfma_f32_32x32x16_bf16 v[160:175], v[20:23], v[48:51], v[160:175]
  ds_read_b64_tr_b16 v[36:37], v65 offset:4096
  ds_read_b64_tr_b16 v[38:39], v65 offset:5120
  v_mfma_f32_32x32x16_bf16 v[176:191], v[20:23], v[52:55], v[176:191]
  v_mfma_f32_16x16x32_bf16 v[116:119], v[72:75], v[20:23], v[116:119]
  ds_read_b64_tr_b16 v[40:41], v66 offset:4096
  ds_read_b64_tr_b16 v[42:43], v66 offset:5120
  s_waitcnt lgkmcnt(10)
  v_mfma_f32_32x32x16_bf16 v[192:207], v[24:27], v[48:51], v[192:207]
  ds_read_b64_tr_b16 v[44:45], v67 offset:4096
  ds_read_b64_tr_b16 v[46:47], v67 offset:5120
  v_mfma_f32_32x32x16_bf16 v[208:223], v[24:27], v[52:55], v[208:223]
  v_mfma_f32_16x16x32_bf16 v[120:123], v[72:75], v[24:27], v[120:123]
  s_waitcnt lgkmcnt(10)
  v_mfma_f32_32x32x16_bf16 v[224:239], v[28:31], v[48:51], v[224:239]
  v_mfma_f32_32x32x16_bf16 v[240:255], v[28:31], v[52:55], v[240:255]
  v_mfma_f32_16x16x32_bf16 v[124:127], v[72:75], v[28:31], v[124:127]
  s_waitcnt lgkmcnt(6)
  v_mfma_f32_32x32x16_bf16 v[128:143], v[32:35], v[56:59], v[128:143]
  v_mfma_f32_32x32x16_bf16 v[144:159], v[32:35], v[60:63], v[144:159]
  s_waitcnt lgkmcnt(4)
  v_mfma_f32_32x32x16_bf16 v[160:175], v[36:39], v[56:59], v[160:175]
  v_mfma_f32_32x32x16_bf16 v[176:191], v[36:39], v[60:63], v[176:191]
  s_waitcnt lgkmcnt(2)
  v_mfma_f32_32x32x16_bf16 v[192:207], v[40:43], v[56:59], v[192:207]
  v_mfma_f32_32x32x16_bf16 v[208:223], v[40:43], v[60:63], v[208:223]
  s_waitcnt lgkmcnt(0)
  v_mfma_f32_32x32x16_bf16 v[224:239], v[44:47], v[56:59], v[224:239]
  v_mfma_f32_32x32x16_bf16 v[240:255], v[44:47], v[60:63], v[240:255]
  s_branch .Lrecurr_upd23
.Lrecurr_th122:
.Lrecurr_uloop25:
  s_waitcnt lgkmcnt(6)
  v_mfma_f32_32x32x16_bf16 v[128:143], v[16:19], v[48:51], v[128:143]
  ds_read_b128 v[56:59], v69 offset:0
  ds_read_b128 v[60:63], v69 offset:2048
  v_mfma_f32_32x32x16_bf16 v[144:159], v[16:19], v[52:55], v[144:159]
  ds_read_b64_tr_b16 v[32:33], v64 offset:4096
  ds_read_b64_tr_b16 v[34:35], v64 offset:5120
  s_waitcnt lgkmcnt(8)
  v_mfma_f32_32x32x16_bf16 v[160:175], v[20:23], v[48:51], v[160:175]
  ds_read_b64_tr_b16 v[36:37], v65 offset:4096
  ds_read_b64_tr_b16 v[38:39], v65 offset:5120
  v_mfma_f32_32x32x16_bf16 v[176:191], v[20:23], v[52:55], v[176:191]
  ds_read_b64_tr_b16 v[40:41], v66 offset:4096
  ds_read_b64_tr_b16 v[42:43], v66 offset:5120
  s_waitcnt lgkmcnt(10)
  v_mfma_f32_32x32x16_bf16 v[192:207], v[24:27], v[48:51], v[192:207]
  ds_read_b64_tr_b16 v[44:45], v67 offset:4096
  ds_read_b64_tr_b16 v[46:47], v67 offset:5120
  v_mfma_f32_32x32x16_bf16 v[208:223], v[24:27], v[52:55], v[208:223]
  s_waitcnt lgkmcnt(10)
  v_mfma_f32_32x32x16_bf16 v[224:239], v[28:31], v[48:51], v[224:239]
  v_mfma_f32_32x32x16_bf16 v[240:255], v[28:31], v[52:55], v[240:255]
  s_waitcnt lgkmcnt(6)
  v_mfma_f32_32x32x16_bf16 v[128:143], v[32:35], v[56:59], v[128:143]
  s_waitcnt vmcnt(6) lgkmcnt(0)
  s_barrier
  ds_read_b128 v[48:51], v68 offset:24576
  ds_read_b128 v[52:55], v68 offset:26624
  v_mfma_f32_32x32x16_bf16 v[144:159], v[32:35], v[60:63], v[144:159]
  v_mfma_f32_16x16x32_bf16 v[112:115], v[72:75], v[32:35], v[112:115]
  ds_read_b64_tr_b16 v[16:17], v64 offset:24576
  ds_read_b64_tr_b16 v[18:19], v64 offset:25600
  v_mfma_f32_32x32x16_bf16 v[160:175], v[36:39], v[56:59], v[160:175]
  ds_read_b64_tr_b16 v[20:21], v65 offset:24576
  ds_read_b64_tr_b16 v[22:23], v65 offset:25600
  s_add_u32 m0, s22, 0
  s_nop 0
  buffer_load_dwordx4 v8, s[36:39], s34 offen offset:0 lds
  v_mfma_f32_32x32x16_bf16 v[176:191], v[36:39], v[60:63], v[176:191]
  v_mfma_f32_16x16x32_bf16 v[116:119], v[72:75], v[36:39], v[116:119]
  ds_read_b64_tr_b16 v[24:25], v66 offset:24576
  ds_read_b64_tr_b16 v[26:27], v66 offset:25600
  buffer_load_dwordx4 v9, s[36:39], s34 offen offset:1024 lds
  v_mfma_f32_32x32x16_bf16 v[192:207], v[40:43], v[56:59], v[192:207]
  ds_read_b64_tr_b16 v[28:29], v67 offset:24576
  ds_read_b64_tr_b16 v[30:31], v67 offset:25600
  s_add_u32 m0, s21, 0
  s_add_u32 s34, s34, 64
  buffer_load_dwordx4 v4, s[24:27], s20 offen offset:0 lds
  v_mfma_f32_32x32x16_bf16 v[208:223], v[40:43], v[60:63], v[208:223]
  v_mfma_f32_16x16x32_bf16 v[120:123], v[72:75], v[40:43], v[120:123]
  buffer_load_dwordx4 v5, s[24:27], s20 offen offset:1024 lds
  v_mfma_f32_32x32x16_bf16 v[224:239], v[44:47], v[56:59], v[224:239]
  buffer_load_dwordx4 v6, s[24:27], s20 offen offset:2048 lds
  v_mfma_f32_32x32x16_bf16 v[240:255], v[44:47], v[60:63], v[240:255]
  v_mfma_f32_16x16x32_bf16 v[124:127], v[72:75], v[44:47], v[124:127]
  buffer_load_dwordx4 v7, s[24:27], s20 offen offset:3072 lds
  s_add_u32 s20, s20, 114688
  s_waitcnt lgkmcnt(6)
  v_mfma_f32_32x32x16_bf16 v[128:143], v[16:19], v[48:51], v[128:143]
  ds_read_b128 v[56:59], v69 offset:24576
  ds_read_b128 v[60:63], v69 offset:26624
  v_mfma_f32_32x32x16_bf16 v[144:159], v[16:19], v[52:55], v[144:159]
  ds_read_b64_tr_b16 v[32:33], v64 offset:28672
  ds_read_b64_tr_b16 v[34:35], v64 offset:29696
  s_waitcnt lgkmcnt(8)
  v_mfma_f32_32x32x16_bf16 v[160:175], v[20:23], v[48:51], v[160:175]
  ds_read_b64_tr_b16 v[36:37], v65 offset:28672
  ds_read_b64_tr_b16 v[38:39], v65 offset:29696
  v_mfma_f32_32x32x16_bf16 v[176:191], v[20:23], v[52:55], v[176:191]
  ds_read_b64_tr_b16 v[40:41], v66 offset:28672
  ds_read_b64_tr_b16 v[42:43], v66 offset:29696
  s_waitcnt lgkmcnt(10)
  v_mfma_f32_32x32x16_bf16 v[192:207], v[24:27], v[48:51], v[192:207]
  ds_read_b64_tr_b16 v[44:45], v67 offset:28672
  ds_read_b64_tr_b16 v[46:47], v67 offset:29696
  v_mfma_f32_32x32x16_bf16 v[208:223], v[24:27], v[52:55], v[208:223]
  s_waitcnt lgkmcnt(10)
  v_mfma_f32_32x32x16_bf16 v[224:239], v[28:31], v[48:51], v[224:239]
  v_mfma_f32_32x32x16_bf16 v[240:255], v[28:31], v[52:55], v[240:255]
  s_waitcnt lgkmcnt(6)
  v_mfma_f32_32x32x16_bf16 v[128:143], v[32:35], v[56:59], v[128:143]
  s_waitcnt vmcnt(6) lgkmcnt(0)
  s_barrier
  ds_read_b128 v[48:51], v68 offset:49152
  ds_read_b128 v[52:55], v68 offset:51200
  v_mfma_f32_32x32x16_bf16 v[144:159], v[32:35], v[60:63], v[144:159]
  v_mfma_f32_16x16x32_bf16 v[112:115], v[72:75], v[32:35], v[112:115]
  ds_read_b64_tr_b16 v[16:17], v64 offset:49152
  ds_read_b64_tr_b16 v[18:19], v64 offset:50176
  v_mfma_f32_32x32x16_bf16 v[160:175], v[36:39], v[56:59], v[160:175]
  ds_read_b64_tr_b16 v[20:21], v65 offset:49152
  ds_read_b64_tr_b16 v[22:23], v65 offset:50176
  s_add_u32 m0, s22, 24576
  s_nop 0
  buffer_load_dwordx4 v8, s[36:39], s34 offen offset:0 lds
  v_mfma_f32_32x32x16_bf16 v[176:191], v[36:39], v[60:63], v[176:191]
  v_mfma_f32_16x16x32_bf16 v[116:119], v[72:75], v[36:39], v[116:119]
  ds_read_b64_tr_b16 v[24:25], v66 offset:49152
  ds_read_b64_tr_b16 v[26:27], v66 offset:50176
  buffer_load_dwordx4 v9, s[36:39], s34 offen offset:1024 lds
  v_mfma_f32_32x32x16_bf16 v[192:207], v[40:43], v[56:59], v[192:207]
  ds_read_b64_tr_b16 v[28:29], v67 offset:49152
  ds_read_b64_tr_b16 v[30:31], v67 offset:50176
  s_add_u32 m0, s21, 24576
  s_add_u32 s34, s34, 64
  buffer_load_dwordx4 v4, s[24:27], s20 offen offset:0 lds
  v_mfma_f32_32x32x16_bf16 v[208:223], v[40:43], v[60:63], v[208:223]
  v_mfma_f32_16x16x32_bf16 v[120:123], v[72:75], v[40:43], v[120:123]
  buffer_load_dwordx4 v5, s[24:27], s20 offen offset:1024 lds
  v_mfma_f32_32x32x16_bf16 v[224:239], v[44:47], v[56:59], v[224:239]
  buffer_load_dwordx4 v6, s[24:27], s20 offen offset:2048 lds
  v_mfma_f32_32x32x16_bf16 v[240:255], v[44:47], v[60:63], v[240:255]
  v_mfma_f32_16x16x32_bf16 v[124:127], v[72:75], v[44:47], v[124:127]
  buffer_load_dwordx4 v7, s[24:27], s20 offen offset:3072 lds
  s_add_u32 s20, s20, 114688
  s_waitcnt lgkmcnt(6)
  v_mfma_f32_32x32x16_bf16 v[128:143], v[16:19], v[48:51], v[128:143]
  ds_read_b128 v[56:59], v69 offset:49152
  ds_read_b128 v[60:63], v69 offset:51200
  v_mfma_f32_32x32x16_bf16 v[144:159], v[16:19], v[52:55], v[144:159]
  ds_read_b64_tr_b16 v[32:33], v64 offset:53248
  ds_read_b64_tr_b16 v[34:35], v64 offset:54272
  s_waitcnt lgkmcnt(8)
  v_mfma_f32_32x32x16_bf16 v[160:175], v[20:23], v[48:51], v[160:175]
  ds_read_b64_tr_b16 v[36:37], v65 offset:53248
  ds_read_b64_tr_b16 v[38:39], v65 offset:54272
  v_mfma_f32_32x32x16_bf16 v[176:191], v[20:23], v[52:55], v[176:191]
  ds_read_b64_tr_b16 v[40:41], v66 offset:53248
  ds_read_b64_tr_b16 v[42:43], v66 offset:54272
  s_waitcnt lgkmcnt(10)
  v_mfma_f32_32x32x16_bf16 v[192:207], v[24:27], v[48:51], v[192:207]
  ds_read_b64_tr_b16 v[44:45], v67 offset:53248
  ds_read_b64_tr_b16 v[46:47], v67 offset:54272
  v_mfma_f32_32x32x16_bf16 v[208:223], v[24:27], v[52:55], v[208:223]
  s_waitcnt lgkmcnt(10)
  v_mfma_f32_32x32x16_bf16 v[224:239], v[28:31], v[48:51], v[224:239]
  s_cmp_lg_u32 s48, 1
  s_cbranch_scc1 .Lskipst1
  buffer_load_dwordx4 v[80:83], v77, s[28:31], s45 offen sc1
  buffer_load_dwordx4 v[84:87], v77, s[28:31], s45 offen offset:512 sc1
.Lskipst1:
  v_mfma_f32_32x32x16_bf16 v[240:255], v[28:31], v[52:55], v[240:255]
  s_waitcnt lgkmcnt(6)
  v_mfma_f32_32x32x16_bf16 v[128:143], v[32:35], v[56:59], v[128:143]
  s_waitcnt vmcnt(6) lgkmcnt(0)
  s_barrier
  ds_read_b128 v[48:51], v68 offset:0
  ds_read_b128 v[52:55], v68 offset:2048
  v_mfma_f32_32x32x16_bf16 v[144:159], v[32:35], v[60:63], v[144:159]
  v_mfma_f32_16x16x32_bf16 v[112:115], v[72:75], v[32:35], v[112:115]
  ds_read_b64_tr_b16 v[16:17], v64 offset:0
  ds_read_b64_tr_b16 v[18:19], v64 offset:1024
  v_mfma_f32_32x32x16_bf16 v[160:175], v[36:39], v[56:59], v[160:175]
  ds_read_b64_tr_b16 v[20:21], v65 offset:0
  ds_read_b64_tr_b16 v[22:23], v65 offset:1024
  s_add_u32 m0, s22, 49152
  s_nop 0
  buffer_load_dwordx4 v8, s[36:39], s34 offen offset:0 lds
  v_mfma_f32_32x32x16_bf16 v[176:191], v[36:39], v[60:63], v[176:191]
  v_mfma_f32_16x16x32_bf16 v[116:119], v[72:75], v[36:39], v[116:119]
  ds_read_b64_tr_b16 v[24:25], v66 offset:0
  ds_read_b64_tr_b16 v[26:27], v66 offset:1024
  buffer_load_dwordx4 v9, s[36:39], s34 offen offset:1024 lds
  v_mfma_f32_32x32x16_bf16 v[192:207], v[40:43], v[56:59], v[192:207]
  ds_read_b64_tr_b16 v[28:29], v67 offset:0
  ds_read_b64_tr_b16 v[30:31], v67 offset:1024
  s_add_u32 m0, s21, 49152
  s_add_u32 s34, s34, 64
  buffer_load_dwordx4 v4, s[24:27], s20 offen offset:0 lds
  v_mfma_f32_32x32x16_bf16 v[208:223], v[40:43], v[60:63], v[208:223]
  v_mfma_f32_16x16x32_bf16 v[120:123], v[72:75], v[40:43], v[120:123]
  buffer_load_dwordx4 v5, s[24:27], s20 offen offset:1024 lds
  v_mfma_f32_32x32x16_bf16 v[224:239], v[44:47], v[56:59], v[224:239]
  buffer_load_dwordx4 v6, s[24:27], s20 offen offset:2048 lds
  v_mfma_f32_32x32x16_bf16 v[240:255], v[44:47], v[60:63], v[240:255]
  v_mfma_f32_16x16x32_bf16 v[124:127], v[72:75], v[44:47], v[124:127]
  buffer_load_dwordx4 v7, s[24:27], s20 offen offset:3072 lds
  s_add_u32 s20, s20, 114688
  s_sub_u32 s48, s48, 1
  s_cmp_lg_u32 s48, 0
  s_cbranch_scc1 .Lrecurr_uloop25
  s_waitcnt lgkmcnt(6)
  v_mfma_f32_32x32x16_bf16 v[128:143], v[16:19], v[48:51], v[128:143]
  ds_read_b128 v[56:59], v69 offset:0
  ds_read_b128 v[60:63], v69 offset:2048
  v_mfma_f32_32x32x16_bf16 v[144:159], v[16:19], v[52:55], v[144:159]
  ds_read_b64_tr_b16 v[32:33], v64 offset:4096
  ds_read_b64_tr_b16 v[34:35], v64 offset:5120
  s_waitcnt lgkmcnt(8)
  v_mfma_f32_32x32x16_bf16 v[160:175], v[20:23], v[48:51], v[160:175]
  ds_read_b64_tr_b16 v[36:37], v65 offset:4096
  ds_read_b64_tr_b16 v[38:39], v65 offset:5120
  v_mfma_f32_32x32x16_bf16 v[176:191], v[20:23], v[52:55], v[176:191]
  ds_read_b64_tr_b16 v[40:41], v66 offset:4096
  ds_read_b64_tr_b16 v[42:43], v66 offset:5120
  s_waitcnt lgkmcnt(10)
  v_mfma_f32_32x32x16_bf16 v[192:207], v[24:27], v[48:51], v[192:207]
  ds_read_b64_tr_b16 v[44:45], v67 offset:4096
  ds_read_b64_tr_b16 v[46:47], v67 offset:5120
  v_mfma_f32_32x32x16_bf16 v[208:223], v[24:27], v[52:55], v[208:223]
  s_waitcnt lgkmcnt(10)
  v_mfma_f32_32x32x16_bf16 v[224:239], v[28:31], v[48:51], v[224:239]
  v_mfma_f32_32x32x16_bf16 v[240:255], v[28:31], v[52:55], v[240:255]
  s_waitcnt lgkmcnt(6)
  v_mfma_f32_32x32x16_bf16 v[128:143], v[32:35], v[56:59], v[128:143]
  v_mfma_f32_32x32x16_bf16 v[144:159], v[32:35], v[60:63], v[144:159]
  v_mfma_f32_16x16x32_bf16 v[112:115], v[72:75], v[32:35], v[112:115]
  s_waitcnt lgkmcnt(4)
  v_mfma_f32_32x32x16_bf16 v[160:175], v[36:39], v[56:59], v[160:175]
  v_mfma_f32_32x32x16_bf16 v[176:191], v[36:39], v[60:63], v[176:191]
  v_mfma_f32_16x16x32_bf16 v[116:119], v[72:75], v[36:39], v[116:119]
  s_waitcnt lgkmcnt(2)
  v_mfma_f32_32x32x16_bf16 v[192:207], v[40:43], v[56:59], v[192:207]
  v_mfma_f32_32x32x16_bf16 v[208:223], v[40:43], v[60:63], v[208:223]
  v_mfma_f32_16x16x32_bf16 v[120:123], v[72:75], v[40:43], v[120:123]
  s_waitcnt lgkmcnt(0)
  v_mfma_f32_32x32x16_bf16 v[224:239], v[44:47], v[56:59], v[224:239]
  v_mfma_f32_32x32x16_bf16 v[240:255], v[44:47], v[60:63], v[240:255]
  v_mfma_f32_16x16x32_bf16 v[124:127], v[72:75], v[44:47], v[124:127]
.Lrecurr_upd23:
  s_setprio 3
  s_mov_b32 s49, 0xffff0000
  v_cvt_pk_bf16_f32 v113, v112, v112
  v_and_b32 v113, s49, v113
  v_sub_f32 v112, v112, v113
  v_cvt_pk_bf16_f32 v112, v112, v113
  ds_write_b32 v70, v112 offset:0
  v_mov_b32 v113, 0
  v_mov_b32 v114, 0
  v_mov_b32 v115, 0
  v_cvt_pk_bf16_f32 v117, v116, v116
  v_and_b32 v117, s49, v117
  v_sub_f32 v116, v116, v117
  v_cvt_pk_bf16_f32 v116, v116, v117
  ds_write_b32 v70, v116 offset:256
  v_mov_b32 v117, 0
  v_mov_b32 v118, 0
  v_mov_b32 v119, 0
  v_cvt_pk_bf16_f32 v121, v120, v120
  v_and_b32 v121, s49, v121
  v_sub_f32 v120, v120, v121
  v_cvt_pk_bf16_f32 v120, v120, v121
  ds_write_b32 v70, v120 offset:512
  v_mov_b32 v121, 0
  v_mov_b32 v122, 0
  v_mov_b32 v123, 0
  v_cvt_pk_bf16_f32 v125, v124, v124
  v_and_b32 v125, s49, v125
  v_sub_f32 v124, v124, v125
  v_cvt_pk_bf16_f32 v124, v124, v125
  ds_write_b32 v70, v124 offset:768
  v_mov_b32 v125, 0
  v_mov_b32 v126, 0
  v_mov_b32 v127, 0
  s_mov_b32 s40, 0xbdd2d3e8
  s_mov_b32 s41, s40
  s_mul_i32 s35, s44, 229376
  s_lshl_b32 s47, s15, 13
  s_add_u32 s35, s35, s47
  s_lshl_b32 s47, s19, 12
  s_add_u32 s35, s35, s47
  s_add_u32 s35, s35, 0x500000
  s_add_u32 s34, s35, 114688
  s_lshl_b32 s44, s44, 13
  s_lshl_b32 s47, s15, 8
  s_add_u32 s44, s44, s47
  s_lshl_b32 s47, s19, 7
  s_add_u32 s44, s44, s47
  s_add_u32 s44, s44, 0xf00000
  s_waitcnt vmcnt(0) lgkmcnt(0)
  s_barrier
  ds_read_b32 v112, v71 offset:0
  ds_read_b32 v116, v71 offset:256
  ds_read_b32 v120, v71 offset:512
  ds_read_b32 v124, v71 offset:768
  s_mov_b32 s60, 0x40000
.Lrecurr_stp26:
  v_cmp_eq_u64 vcc, s[58:59], v[82:83]
  v_cmp_eq_u64 s[62:63], s[58:59], v[86:87]
  s_and_b64 vcc, vcc, s[62:63]
  s_cmp_eq_u64 vcc, -1
  s_cbranch_scc1 .Lrecurr_stpd27
  s_sleep 4
.Lrecurr_stpl28:
  buffer_load_dwordx4 v[80:83], v77, s[28:31], s45 offen sc1
  buffer_load_dwordx4 v[84:87], v77, s[28:31], s45 offen offset:512 sc1
  s_waitcnt vmcnt(0)
  s_sub_u32 s60, s60, 1
  s_cmp_lg_u32 s60, 0
  s_cbranch_scc1 .Lrecurr_stp26
.Lrecurr_stpd27:
  v_lshrrev_b32 v48, 16, v80
  v_or_b32 v48, v48, v80
  v_mov_b32 v49, 0
  v_mov_b32 v50, 0
  v_mov_b32 v51, 0
  v_rcp_f32 v82, v81
  v_mov_b32 v80, v81
  v_mov_b32 v83, v82
  v_lshrrev_b32 v52, 16, v84
  v_or_b32 v52, v52, v84
  v_mov_b32 v53, 0
  v_mov_b32 v54, 0
  v_mov_b32 v55, 0
  v_rcp_f32 v86, v85
  v_mov_b32 v84, v85
  v_mov_b32 v87, v86
  s_waitcnt lgkmcnt(0)
  v_mfma_f32_32x32x16_bf16 v[128:143], v[112:115], v[48:51], v[128:143]
  v_mfma_f32_32x32x16_bf16 v[144:159], v[112:115], v[52:55], v[144:159]
  v_mfma_f32_32x32x16_bf16 v[160:175], v[116:119], v[48:51], v[160:175]
  v_mfma_f32_32x32x16_bf16 v[176:191], v[116:119], v[52:55], v[176:191]
  v_mfma_f32_32x32x16_bf16 v[192:207], v[120:123], v[48:51], v[192:207]
  v_mfma_f32_32x32x16_bf16 v[208:223], v[120:123], v[52:55], v[208:223]
  v_mfma_f32_32x32x16_bf16 v[224:239], v[124:127], v[48:51], v[224:239]
  v_mfma_f32_32x32x16_bf16 v[240:255], v[124:127], v[52:55], v[240:255]
  s_and_b32 s14, s3, 7
  s_lshl_b32 s14, s14, 2
  s_lshr_b32 s15, s3, 6
  s_add_u32 s14, s14, s15
  s_bfe_u32 s15, s3, 0x30003
  s_mul_i32 s18, s16, 458752
  s_lshl_b32 s20, s15, 7
  s_add_u32 s18, s18, s20
  s_lshl_b32 s22, s16, 17
  s_add_u32 s22, s22, s20
  s_mov_b32 s24, s52
  s_mov_b32 s25, s53
  s_mov_b32 s26, 0x1c0000
  s_mov_b32 s27, 0x20000
  s_mov_b32 s4, s10
  s_mov_b32 s5, s11
  s_mov_b32 s6, 0x80000
  s_mov_b32 s7, 0x20000
  s_add_u32 m0, s17, 0
  s_nop 0
  buffer_load_dwordx4 v104, s[4:7], s22 offen lds
  buffer_load_dwordx4 v105, s[4:7], s22 offen offset:1024 lds
  s_add_u32 s22, s22, 0x4000
  s_add_u32 m0, s17, 2048
  s_nop 0
  buffer_load_dwordx4 v104, s[4:7], s22 offen lds
  buffer_load_dwordx4 v105, s[4:7], s22 offen offset:1024 lds
  s_add_u32 s22, s22, 0x4000
  v_pk_mul_f32 v[128:129], v[128:129], v[82:83]
  v_pk_mul_f32 v[130:131], v[130:131], v[82:83]
  v_pk_mul_f32 v[132:133], v[132:133], v[82:83]
  v_pk_mul_f32 v[134:135], v[134:135], v[82:83]
  v_pk_mul_f32 v[16:17], v[128:129], v[128:129]
  v_pk_mul_f32 v[18:19], v[130:131], v[130:131]
  v_pk_mul_f32 v[20:21], v[132:133], v[132:133]
  v_pk_mul_f32 v[22:23], v[134:135], v[134:135]
  v_pk_fma_f32 v[16:17], v[16:17], s[40:41], v[12:13]
  v_pk_fma_f32 v[18:19], v[18:19], s[40:41], v[12:13]
  v_pk_fma_f32 v[20:21], v[20:21], s[40:41], v[12:13]
  v_pk_fma_f32 v[22:23], v[22:23], s[40:41], v[12:13]
  v_pk_mul_f32 v[16:17], v[16:17], v[128:129]
  v_pk_mul_f32 v[18:19], v[18:19], v[130:131]
  v_pk_mul_f32 v[20:21], v[20:21], v[132:133]
  v_pk_mul_f32 v[22:23], v[22:23], v[134:135]
  v_exp_f32 v16, v16
  v_exp_f32 v17, v17
  v_exp_f32 v18, v18
  v_exp_f32 v19, v19
  v_exp_f32 v20, v20
  v_exp_f32 v21, v21
  v_exp_f32 v22, v22
  v_exp_f32 v23, v23
  v_pk_mul_f32 v[128:129], v[128:129], v[136:137]
  v_pk_mul_f32 v[130:131], v[130:131], v[138:139]
  v_pk_mul_f32 v[132:133], v[132:133], v[140:141]
  v_pk_mul_f32 v[134:135], v[134:135], v[142:143]
  v_pk_fma_f32 v[16:17], v[16:17], v[80:81], v[80:81]
  v_pk_fma_f32 v[18:19], v[18:19], v[80:81], v[80:81]
  v_pk_fma_f32 v[20:21], v[20:21], v[80:81], v[80:81]
  v_pk_fma_f32 v[22:23], v[22:23], v[80:81], v[80:81]
  v_rcp_f32 v16, v16
  v_rcp_f32 v17, v17
  v_rcp_f32 v18, v18
  v_rcp_f32 v19, v19
  v_rcp_f32 v20, v20
  v_rcp_f32 v21, v21
  v_rcp_f32 v22, v22
  v_rcp_f32 v23, v23
  s_nop 0
  v_pk_mul_f32 v[128:129], v[128:129], v[16:17]
  v_pk_mul_f32 v[130:131], v[130:131], v[18:19]
  v_pk_mul_f32 v[132:133], v[132:133], v[20:21]
  v_pk_mul_f32 v[134:135], v[134:135], v[22:23]
  v_cvt_pk_bf16_f32 v24, v128, v129
  v_cvt_pk_bf16_f32 v25, v130, v131
  v_cvt_pk_bf16_f32 v26, v132, v133
  v_cvt_pk_bf16_f32 v27, v134, v135
  buffer_store_dwordx4 v[24:27], v3, s[28:31], s35 offen offset:0 sc1
  s_add_u32 m0, s17, 4096
  s_nop 0
  buffer_load_dwordx4 v104, s[4:7], s22 offen lds
  buffer_load_dwordx4 v105, s[4:7], s22 offen offset:1024 lds
  s_add_u32 s22, s22, 0x4000
  s_add_u32 m0, s17, 6144
  s_nop 0
  buffer_load_dwordx4 v104, s[4:7], s22 offen lds
  buffer_load_dwordx4 v105, s[4:7], s22 offen offset:1024 lds
  s_add_u32 s22, s22, 0x4000
  v_pk_mul_f32 v[144:145], v[144:145], v[86:87]
  v_pk_mul_f32 v[146:147], v[146:147], v[86:87]
  v_pk_mul_f32 v[148:149], v[148:149], v[86:87]
  v_pk_mul_f32 v[150:151], v[150:151], v[86:87]
  v_pk_mul_f32 v[32:33], v[144:145], v[144:145]
  v_pk_mul_f32 v[34:35], v[146:147], v[146:147]
  v_pk_mul_f32 v[36:37], v[148:149], v[148:149]
  v_pk_mul_f32 v[38:39], v[150:151], v[150:151]
  v_pk_fma_f32 v[32:33], v[32:33], s[40:41], v[12:13]
  v_pk_fma_f32 v[34:35], v[34:35], s[40:41], v[12:13]
  v_pk_fma_f32 v[36:37], v[36:37], s[40:41], v[12:13]
  v_pk_fma_f32 v[38:39], v[38:39], s[40:41], v[12:13]
  v_pk_mul_f32 v[32:33], v[32:33], v[144:145]
  v_pk_mul_f32 v[34:35], v[34:35], v[146:147]
  v_pk_mul_f32 v[36:37], v[36:37], v[148:149]
  v_pk_mul_f32 v[38:39], v[38:39], v[150:151]
  v_exp_f32 v32, v32
  v_exp_f32 v33, v33
  v_exp_f32 v34, v34
  v_exp_f32 v35, v35
  v_exp_f32 v36, v36
  v_exp_f32 v37, v37
  v_exp_f32 v38, v38
  v_exp_f32 v39, v39
  v_pk_mul_f32 v[144:145], v[144:145], v[152:153]
  v_pk_mul_f32 v[146:147], v[146:147], v[154:155]
  v_pk_mul_f32 v[148:149], v[148:149], v[156:157]
  v_pk_mul_f32 v[150:151], v[150:151], v[158:159]
  v_pk_fma_f32 v[32:33], v[32:33], v[84:85], v[84:85]
  v_pk_fma_f32 v[34:35], v[34:35], v[84:85], v[84:85]
  v_pk_fma_f32 v[36:37], v[36:37], v[84:85], v[84:85]
  v_pk_fma_f32 v[38:39], v[38:39], v[84:85], v[84:85]
  v_rcp_f32 v32, v32
  v_rcp_f32 v33, v33
  v_rcp_f32 v34, v34
  v_rcp_f32 v35, v35
  v_rcp_f32 v36, v36
  v_rcp_f32 v37, v37
  v_rcp_f32 v38, v38
  v_rcp_f32 v39, v39
  s_nop 0
  v_pk_mul_f32 v[144:145], v[144:145], v[32:33]
  v_pk_mul_f32 v[146:147], v[146:147], v[34:35]
  v_pk_mul_f32 v[148:149], v[148:149], v[36:37]
  v_pk_mul_f32 v[150:151], v[150:151], v[38:39]
  v_cvt_pk_bf16_f32 v40, v144, v145
  v_cvt_pk_bf16_f32 v41, v146, v147
  v_cvt_pk_bf16_f32 v42, v148, v149
  v_cvt_pk_bf16_f32 v43, v150, v151
  buffer_store_dwordx4 v[40:43], v3, s[28:31], s34 offen offset:0 sc1
  s_add_u32 m0, s17, 8192
  s_nop 0
  buffer_load_dwordx4 v104, s[4:7], s22 offen lds
  buffer_load_dwordx4 v105, s[4:7], s22 offen offset:1024 lds
  s_add_u32 s22, s22, 0x4000
  s_add_u32 m0, s17, 10240
  s_nop 0
  buffer_load_dwordx4 v104, s[4:7], s22 offen lds
  buffer_load_dwordx4 v105, s[4:7], s22 offen offset:1024 lds
  s_add_u32 s22, s22, 0x4000
  v_pk_mul_f32 v[160:161], v[160:161], v[82:83]
  v_pk_mul_f32 v[162:163], v[162:163], v[82:83]
  v_pk_mul_f32 v[164:165], v[164:165], v[82:83]
  v_pk_mul_f32 v[166:167], v[166:167], v[82:83]
  v_pk_mul_f32 v[16:17], v[160:161], v[160:161]
  v_pk_mul_f32 v[18:19], v[162:163], v[162:163]
  v_pk_mul_f32 v[20:21], v[164:165], v[164:165]
  v_pk_mul_f32 v[22:23], v[166:167], v[166:167]
  v_pk_fma_f32 v[16:17], v[16:17], s[40:41], v[12:13]
  v_pk_fma_f32 v[18:19], v[18:19], s[40:41], v[12:13]
  v_pk_fma_f32 v[20:21], v[20:21], s[40:41], v[12:13]
  v_pk_fma_f32 v[22:23], v[22:23], s[40:41], v[12:13]
  v_pk_mul_f32 v[16:17], v[16:17], v[160:161]
  v_pk_mul_f32 v[18:19], v[18:19], v[162:163]
  v_pk_mul_f32 v[20:21], v[20:21], v[164:165]
  v_pk_mul_f32 v[22:23], v[22:23], v[166:167]
  v_exp_f32 v16, v16
  v_exp_f32 v17, v17
  v_exp_f32 v18, v18
  v_exp_f32 v19, v19
  v_exp_f32 v20, v20
  v_exp_f32 v21, v21
  v_exp_f32 v22, v22
  v_exp_f32 v23, v23
  v_pk_mul_f32 v[160:161], v[160:161], v[168:169]
  v_pk_mul_f32 v[162:163], v[162:163], v[170:171]
  v_pk_mul_f32 v[164:165], v[164:165], v[172:173]
  v_pk_mul_f32 v[166:167], v[166:167], v[174:175]
  v_pk_fma_f32 v[16:17], v[16:17], v[80:81], v[80:81]
  v_pk_fma_f32 v[18:19], v[18:19], v[80:81], v[80:81]
  v_pk_fma_f32 v[20:21], v[20:21], v[80:81], v[80:81]
  v_pk_fma_f32 v[22:23], v[22:23], v[80:81], v[80:81]
  v_rcp_f32 v16, v16
  v_rcp_f32 v17, v17
  v_rcp_f32 v18, v18
  v_rcp_f32 v19, v19
  v_rcp_f32 v20, v20
  v_rcp_f32 v21, v21
  v_rcp_f32 v22, v22
  v_rcp_f32 v23, v23
  s_nop 0
  v_pk_mul_f32 v[160:161], v[160:161], v[16:17]
  v_pk_mul_f32 v[162:163], v[162:163], v[18:19]
  v_pk_mul_f32 v[164:165], v[164:165], v[20:21]
  v_pk_mul_f32 v[166:167], v[166:167], v[22:23]
  v_cvt_pk_bf16_f32 v24, v160, v161
  v_cvt_pk_bf16_f32 v25, v162, v163
  v_cvt_pk_bf16_f32 v26, v164, v165
  v_cvt_pk_bf16_f32 v27, v166, v167
  buffer_store_dwordx4 v[24:27], v3, s[28:31], s35 offen offset:1024 sc1
  s_add_u32 m0, s17, 12288
  s_nop 0
  buffer_load_dwordx4 v104, s[4:7], s22 offen lds
  buffer_load_dwordx4 v105, s[4:7], s22 offen offset:1024 lds
  s_add_u32 s22, s22, 0x4000
  s_add_u32 m0, s17, 14336
  s_nop 0
  buffer_load_dwordx4 v104, s[4:7], s22 offen lds
  buffer_load_dwordx4 v105, s[4:7], s22 offen offset:1024 lds
  s_add_u32 s22, s22, 0x4000
  v_pk_mul_f32 v[176:177], v[176:177], v[86:87]
  v_pk_mul_f32 v[178:179], v[178:179], v[86:87]
  v_pk_mul_f32 v[180:181], v[180:181], v[86:87]
  v_pk_mul_f32 v[182:183], v[182:183], v[86:87]
  v_pk_mul_f32 v[32:33], v[176:177], v[176:177]
  v_pk_mul_f32 v[34:35], v[178:179], v[178:179]
  v_pk_mul_f32 v[36:37], v[180:181], v[180:181]
  v_pk_mul_f32 v[38:39], v[182:183], v[182:183]
  v_pk_fma_f32 v[32:33], v[32:33], s[40:41], v[12:13]
  v_pk_fma_f32 v[34:35], v[34:35], s[40:41], v[12:13]
  v_pk_fma_f32 v[36:37], v[36:37], s[40:41], v[12:13]
  v_pk_fma_f32 v[38:39], v[38:39], s[40:41], v[12:13]
  v_pk_mul_f32 v[32:33], v[32:33], v[176:177]
  v_pk_mul_f32 v[34:35], v[34:35], v[178:179]
  v_pk_mul_f32 v[36:37], v[36:37], v[180:181]
  v_pk_mul_f32 v[38:39], v[38:39], v[182:183]
  v_exp_f32 v32, v32
  v_exp_f32 v33, v33
  v_exp_f32 v34, v34
  v_exp_f32 v35, v35
  v_exp_f32 v36, v36
  v_exp_f32 v37, v37
  v_exp_f32 v38, v38
  v_exp_f32 v39, v39
  v_pk_mul_f32 v[176:177], v[176:177], v[184:185]
  v_pk_mul_f32 v[178:179], v[178:179], v[186:187]
  v_pk_mul_f32 v[180:181], v[180:181], v[188:189]
  v_pk_mul_f32 v[182:183], v[182:183], v[190:191]
  v_pk_fma_f32 v[32:33], v[32:33], v[84:85], v[84:85]
  v_pk_fma_f32 v[34:35], v[34:35], v[84:85], v[84:85]
  v_pk_fma_f32 v[36:37], v[36:37], v[84:85], v[84:85]
  v_pk_fma_f32 v[38:39], v[38:39], v[84:85], v[84:85]
  v_rcp_f32 v32, v32
  v_rcp_f32 v33, v33
  v_rcp_f32 v34, v34
  v_rcp_f32 v35, v35
  v_rcp_f32 v36, v36
  v_rcp_f32 v37, v37
  v_rcp_f32 v38, v38
  v_rcp_f32 v39, v39
  s_nop 0
  v_pk_mul_f32 v[176:177], v[176:177], v[32:33]
  v_pk_mul_f32 v[178:179], v[178:179], v[34:35]
  v_pk_mul_f32 v[180:181], v[180:181], v[36:37]
  v_pk_mul_f32 v[182:183], v[182:183], v[38:39]
  v_cvt_pk_bf16_f32 v40, v176, v177
  v_cvt_pk_bf16_f32 v41, v178, v179
  v_cvt_pk_bf16_f32 v42, v180, v181
  v_cvt_pk_bf16_f32 v43, v182, v183
  buffer_store_dwordx4 v[40:43], v3, s[28:31], s34 offen offset:1024 sc1
  v_pk_mul_f32 v[192:193], v[192:193], v[82:83]
  v_pk_mul_f32 v[194:195], v[194:195], v[82:83]
  v_pk_mul_f32 v[196:197], v[196:197], v[82:83]
  v_pk_mul_f32 v[198:199], v[198:199], v[82:83]
  v_pk_mul_f32 v[16:17], v[192:193], v[192:193]
  v_pk_mul_f32 v[18:19], v[194:195], v[194:195]
  v_pk_mul_f32 v[20:21], v[196:197], v[196:197]
  v_pk_mul_f32 v[22:23], v[198:199], v[198:199]
  v_pk_fma_f32 v[16:17], v[16:17], s[40:41], v[12:13]
  v_pk_fma_f32 v[18:19], v[18:19], s[40:41], v[12:13]
  v_pk_fma_f32 v[20:21], v[20:21], s[40:41], v[12:13]
  v_pk_fma_f32 v[22:23], v[22:23], s[40:41], v[12:13]
  v_pk_mul_f32 v[16:17], v[16:17], v[192:193]
  v_pk_mul_f32 v[18:19], v[18:19], v[194:195]
  v_pk_mul_f32 v[20:21], v[20:21], v[196:197]
  v_pk_mul_f32 v[22:23], v[22:23], v[198:199]
  v_exp_f32 v16, v16
  v_exp_f32 v17, v17
  v_exp_f32 v18, v18
  v_exp_f32 v19, v19
  v_exp_f32 v20, v20
  v_exp_f32 v21, v21
  v_exp_f32 v22, v22
  v_exp_f32 v23, v23
  v_pk_mul_f32 v[192:193], v[192:193], v[200:201]
  v_pk_mul_f32 v[194:195], v[194:195], v[202:203]
  v_pk_mul_f32 v[196:197], v[196:197], v[204:205]
  v_pk_mul_f32 v[198:199], v[198:199], v[206:207]
  v_pk_fma_f32 v[16:17], v[16:17], v[80:81], v[80:81]
  v_pk_fma_f32 v[18:19], v[18:19], v[80:81], v[80:81]
  v_pk_fma_f32 v[20:21], v[20:21], v[80:81], v[80:81]
  v_pk_fma_f32 v[22:23], v[22:23], v[80:81], v[80:81]
  v_rcp_f32 v16, v16
  v_rcp_f32 v17, v17
  v_rcp_f32 v18, v18
  v_rcp_f32 v19, v19
  v_rcp_f32 v20, v20
  v_rcp_f32 v21, v21
  v_rcp_f32 v22, v22
  v_rcp_f32 v23, v23
  s_nop 0
  v_pk_mul_f32 v[192:193], v[192:193], v[16:17]
  v_pk_mul_f32 v[194:195], v[194:195], v[18:19]
  v_pk_mul_f32 v[196:197], v[196:197], v[20:21]
  v_pk_mul_f32 v[198:199], v[198:199], v[22:23]
  v_cvt_pk_bf16_f32 v24, v192, v193
  v_cvt_pk_bf16_f32 v25, v194, v195
  v_cvt_pk_bf16_f32 v26, v196, v197
  v_cvt_pk_bf16_f32 v27, v198, v199
  buffer_store_dwordx4 v[24:27], v3, s[28:31], s35 offen offset:2048 sc1
  s_mul_i32 s19, s14, 229376
  s_mul_i32 s21, s16, 28672
  s_add_u32 s19, s19, s21
  s_add_u32 s19, s19, 0x500000
  s_lshl_b32 s23, s14, 16
  s_lshl_b32 s21, s16, 13
  s_add_u32 s23, s23, s21
  s_add_u32 s23, s23, 0xc00000
  s_lshl_b32 s46, s14, 16
  s_lshl_b32 s21, s16, 14
  s_add_u32 s46, s46, s21
  s_add_u32 s46, s46, s20
  s_add_u32 s47, s46, 8192
  s_lshl_b32 s53, s14, 12
  s_add_u32 s53, s53, 0xe40000
  s_lshl_b32 s52, s14, 13
  s_mul_i32 s21, s16, 896
  s_add_u32 s52, s52, s21
  s_add_u32 s52, s52, 0xf00000
  s_add_u32 s33, s52, 4096
  v_pk_mul_f32 v[208:209], v[208:209], v[86:87]
  v_pk_mul_f32 v[210:211], v[210:211], v[86:87]
  v_pk_mul_f32 v[212:213], v[212:213], v[86:87]
  v_pk_mul_f32 v[214:215], v[214:215], v[86:87]
  v_pk_mul_f32 v[32:33], v[208:209], v[208:209]
  v_pk_mul_f32 v[34:35], v[210:211], v[210:211]
  v_pk_mul_f32 v[36:37], v[212:213], v[212:213]
  v_pk_mul_f32 v[38:39], v[214:215], v[214:215]
  v_pk_fma_f32 v[32:33], v[32:33], s[40:41], v[12:13]
  v_pk_fma_f32 v[34:35], v[34:35], s[40:41], v[12:13]
  v_pk_fma_f32 v[36:37], v[36:37], s[40:41], v[12:13]
  v_pk_fma_f32 v[38:39], v[38:39], s[40:41], v[12:13]
  v_pk_mul_f32 v[32:33], v[32:33], v[208:209]
  v_pk_mul_f32 v[34:35], v[34:35], v[210:211]
  v_pk_mul_f32 v[36:37], v[36:37], v[212:213]
  v_pk_mul_f32 v[38:39], v[38:39], v[214:215]
  v_exp_f32 v32, v32
  v_exp_f32 v33, v33
  v_exp_f32 v34, v34
  v_exp_f32 v35, v35
  v_exp_f32 v36, v36
  v_exp_f32 v37, v37
  v_exp_f32 v38, v38
  v_exp_f32 v39, v39
  v_pk_mul_f32 v[208:209], v[208:209], v[216:217]
  v_pk_mul_f32 v[210:211], v[210:211], v[218:219]
  v_pk_mul_f32 v[212:213], v[212:213], v[220:221]
  v_pk_mul_f32 v[214:215], v[214:215], v[222:223]
  v_pk_fma_f32 v[32:33], v[32:33], v[84:85], v[84:85]
  v_pk_fma_f32 v[34:35], v[34:35], v[84:85], v[84:85]
  v_pk_fma_f32 v[36:37], v[36:37], v[84:85], v[84:85]
  v_pk_fma_f32 v[38:39], v[38:39], v[84:85], v[84:85]
  v_rcp_f32 v32, v32
  v_rcp_f32 v33, v33
  v_rcp_f32 v34, v34
  v_rcp_f32 v35, v35
  v_rcp_f32 v36, v36
  v_rcp_f32 v37, v37
  v_rcp_f32 v38, v38
  v_rcp_f32 v39, v39
  s_nop 0
  v_pk_mul_f32 v[208:209], v[208:209], v[32:33]
  v_pk_mul_f32 v[210:211], v[210:211], v[34:35]
  v_pk_mul_f32 v[212:213], v[212:213], v[36:37]
  v_pk_mul_f32 v[214:215], v[214:215], v[38:39]
  v_cvt_pk_bf16_f32 v40, v208, v209
  v_cvt_pk_bf16_f32 v41, v210, v211
  v_cvt_pk_bf16_f32 v42, v212, v213
  v_cvt_pk_bf16_f32 v43, v214, v215
  buffer_store_dwordx4 v[40:43], v3, s[28:31], s34 offen offset:2048 sc1
  v_mov_b32 v60, s58
  v_mov_b32 v61, s59
  v_lshlrev_b32 v62, 3, v2
  s_waitcnt vmcnt(2)
  s_mov_b64 exec, 65535
  buffer_store_dwordx2 v[60:61], v62, s[28:31], s44 offen sc1
  s_mov_b64 exec, -1
  ds_read_b64_tr_b16 v[128:129], v108 offset:0
  ds_read_b64_tr_b16 v[130:131], v108 offset:1024
  ds_read_b64_tr_b16 v[132:133], v109 offset:0
  ds_read_b64_tr_b16 v[134:135], v109 offset:1024
  ds_read_b64_tr_b16 v[136:137], v108 offset:2048
  ds_read_b64_tr_b16 v[138:139], v108 offset:3072
  ds_read_b64_tr_b16 v[140:141], v109 offset:2048
  ds_read_b64_tr_b16 v[142:143], v109 offset:3072
  ds_read_b64_tr_b16 v[144:145], v108 offset:4096
  ds_read_b64_tr_b16 v[146:147], v108 offset:5120
  ds_read_b64_tr_b16 v[148:149], v109 offset:4096
  ds_read_b64_tr_b16 v[150:151], v109 offset:5120
  ds_read_b64_tr_b16 v[152:153], v108 offset:6144
  ds_read_b64_tr_b16 v[154:155], v108 offset:7168
  ds_read_b64_tr_b16 v[156:157], v109 offset:6144
  ds_read_b64_tr_b16 v[158:159], v109 offset:7168
  ds_read_b64_tr_b16 v[160:161], v108 offset:8192
  ds_read_b64_tr_b16 v[162:163], v108 offset:9216
  ds_read_b64_tr_b16 v[164:165], v109 offset:8192
  ds_read_b64_tr_b16 v[166:167], v109 offset:9216
  ds_read_b64_tr_b16 v[168:169], v108 offset:10240
  ds_read_b64_tr_b16 v[170:171], v108 offset:11264
  ds_read_b64_tr_b16 v[172:173], v109 offset:10240
  ds_read_b64_tr_b16 v[174:175], v109 offset:11264
  ds_read_b64_tr_b16 v[176:177], v108 offset:12288
  ds_read_b64_tr_b16 v[178:179], v108 offset:13312
  ds_read_b64_tr_b16 v[180:181], v109 offset:12288
  ds_read_b64_tr_b16 v[182:183], v109 offset:13312
  ds_read_b64_tr_b16 v[184:185], v108 offset:14336
  ds_read_b64_tr_b16 v[186:187], v108 offset:15360
  ds_read_b64_tr_b16 v[188:189], v109 offset:14336
  ds_read_b64_tr_b16 v[190:191], v109 offset:15360
  v_pk_mul_f32 v[224:225], v[224:225], v[82:83]
  v_pk_mul_f32 v[226:227], v[226:227], v[82:83]
  v_pk_mul_f32 v[228:229], v[228:229], v[82:83]
  v_pk_mul_f32 v[230:231], v[230:231], v[82:83]
  v_pk_mul_f32 v[16:17], v[224:225], v[224:225]
  v_pk_mul_f32 v[18:19], v[226:227], v[226:227]
  v_pk_mul_f32 v[20:21], v[228:229], v[228:229]
  v_pk_mul_f32 v[22:23], v[230:231], v[230:231]
  v_pk_fma_f32 v[16:17], v[16:17], s[40:41], v[12:13]
  v_pk_fma_f32 v[18:19], v[18:19], s[40:41], v[12:13]
  v_pk_fma_f32 v[20:21], v[20:21], s[40:41], v[12:13]
  v_pk_fma_f32 v[22:23], v[22:23], s[40:41], v[12:13]
  v_pk_mul_f32 v[16:17], v[16:17], v[224:225]
  v_pk_mul_f32 v[18:19], v[18:19], v[226:227]
  v_pk_mul_f32 v[20:21], v[20:21], v[228:229]
  v_pk_mul_f32 v[22:23], v[22:23], v[230:231]
  v_exp_f32 v16, v16
  v_exp_f32 v17, v17
  v_exp_f32 v18, v18
  v_exp_f32 v19, v19
  v_exp_f32 v20, v20
  v_exp_f32 v21, v21
  v_exp_f32 v22, v22
  v_exp_f32 v23, v23
  v_pk_mul_f32 v[224:225], v[224:225], v[232:233]
  v_pk_mul_f32 v[226:227], v[226:227], v[234:235]
  v_pk_mul_f32 v[228:229], v[228:229], v[236:237]
  v_pk_mul_f32 v[230:231], v[230:231], v[238:239]
  v_pk_fma_f32 v[16:17], v[16:17], v[80:81], v[80:81]
  v_pk_fma_f32 v[18:19], v[18:19], v[80:81], v[80:81]
  v_pk_fma_f32 v[20:21], v[20:21], v[80:81], v[80:81]
  v_pk_fma_f32 v[22:23], v[22:23], v[80:81], v[80:81]
  v_rcp_f32 v16, v16
  v_rcp_f32 v17, v17
  v_rcp_f32 v18, v18
  v_rcp_f32 v19, v19
  v_rcp_f32 v20, v20
  v_rcp_f32 v21, v21
  v_rcp_f32 v22, v22
  v_rcp_f32 v23, v23
  s_nop 0
  v_pk_mul_f32 v[224:225], v[224:225], v[16:17]
  v_pk_mul_f32 v[226:227], v[226:227], v[18:19]
  v_pk_mul_f32 v[228:229], v[228:229], v[20:21]
  v_pk_mul_f32 v[230:231], v[230:231], v[22:23]
  v_cvt_pk_bf16_f32 v24, v224, v225
  v_cvt_pk_bf16_f32 v25, v226, v227
  v_cvt_pk_bf16_f32 v26, v228, v229
  v_cvt_pk_bf16_f32 v27, v230, v231
  buffer_store_dwordx4 v[24:27], v3, s[28:31], s35 offen offset:3072 sc1
  buffer_load_dwordx2 v[4:5], v15, s[28:31], s52 offen sc1
  s_waitcnt lgkmcnt(0)
  s_add_u32 m0, s17, 0
  s_nop 0
  buffer_load_dwordx4 v104, s[24:27], s18 offen lds
  buffer_load_dwordx4 v105, s[24:27], s18 offen offset:1024 lds
  s_add_u32 s18, s18, 0x4000
  s_add_u32 m0, s17, 2048
  s_nop 0
  buffer_load_dwordx4 v104, s[24:27], s18 offen lds
  buffer_load_dwordx4 v105, s[24:27], s18 offen offset:1024 lds
  s_add_u32 s18, s18, 0xc000
  s_add_u32 m0, s17, 4096
  s_nop 0
  buffer_load_dwordx4 v104, s[24:27], s18 offen lds
  buffer_load_dwordx4 v105, s[24:27], s18 offen offset:1024 lds
  s_add_u32 s18, s18, 0x4000
  s_add_u32 m0, s17, 6144
  s_nop 0
  buffer_load_dwordx4 v104, s[24:27], s18 offen lds
  buffer_load_dwordx4 v105, s[24:27], s18 offen offset:1024 lds
  s_add_u32 s18, s18, 0xc000
  s_add_u32 m0, s17, 8192
  s_nop 0
  buffer_load_dwordx4 v104, s[24:27], s18 offen lds
  buffer_load_dwordx4 v105, s[24:27], s18 offen offset:1024 lds
  s_add_u32 s18, s18, 0x4000
  s_add_u32 m0, s17, 10240
  s_nop 0
  buffer_load_dwordx4 v104, s[24:27], s18 offen lds
  buffer_load_dwordx4 v105, s[24:27], s18 offen offset:1024 lds
  s_add_u32 s18, s18, 0xc000
  s_add_u32 m0, s17, 12288
  s_nop 0
  buffer_load_dwordx4 v104, s[24:27], s18 offen lds
  buffer_load_dwordx4 v105, s[24:27], s18 offen offset:1024 lds
  s_add_u32 s18, s18, 0x4000
  v_pk_mul_f32 v[240:241], v[240:241], v[86:87]
  v_pk_mul_f32 v[242:243], v[242:243], v[86:87]
  v_pk_mul_f32 v[244:245], v[244:245], v[86:87]
  v_pk_mul_f32 v[246:247], v[246:247], v[86:87]
  v_pk_mul_f32 v[32:33], v[240:241], v[240:241]
  v_pk_mul_f32 v[34:35], v[242:243], v[242:243]
  v_pk_mul_f32 v[36:37], v[244:245], v[244:245]
  v_pk_mul_f32 v[38:39], v[246:247], v[246:247]
  v_pk_fma_f32 v[32:33], v[32:33], s[40:41], v[12:13]
  v_pk_fma_f32 v[34:35], v[34:35], s[40:41], v[12:13]
  v_pk_fma_f32 v[36:37], v[36:37], s[40:41], v[12:13]
  v_pk_fma_f32 v[38:39], v[38:39], s[40:41], v[12:13]
  v_pk_mul_f32 v[32:33], v[32:33], v[240:241]
  v_pk_mul_f32 v[34:35], v[34:35], v[242:243]
  v_pk_mul_f32 v[36:37], v[36:37], v[244:245]
  v_pk_mul_f32 v[38:39], v[38:39], v[246:247]
  v_exp_f32 v32, v32
  v_exp_f32 v33, v33
  v_exp_f32 v34, v34
  v_exp_f32 v35, v35
  v_exp_f32 v36, v36
  v_exp_f32 v37, v37
  v_exp_f32 v38, v38
  v_exp_f32 v39, v39
  v_pk_mul_f32 v[240:241], v[240:241], v[248:249]
  v_pk_mul_f32 v[242:243], v[242:243], v[250:251]
  v_pk_mul_f32 v[244:245], v[244:245], v[252:253]
  v_pk_mul_f32 v[246:247], v[246:247], v[254:255]
  v_pk_fma_f32 v[32:33], v[32:33], v[84:85], v[84:85]
  v_pk_fma_f32 v[34:35], v[34:35], v[84:85], v[84:85]
  v_pk_fma_f32 v[36:37], v[36:37], v[84:85], v[84:85]
  v_pk_fma_f32 v[38:39], v[38:39], v[84:85], v[84:85]
  v_rcp_f32 v32, v32
  v_rcp_f32 v33, v33
  v_rcp_f32 v34, v34
  v_rcp_f32 v35, v35
  v_rcp_f32 v36, v36
  v_rcp_f32 v37, v37
  v_rcp_f32 v38, v38
  v_rcp_f32 v39, v39
  s_nop 0
  v_pk_mul_f32 v[240:241], v[240:241], v[32:33]
  v_pk_mul_f32 v[242:243], v[242:243], v[34:35]
  v_pk_mul_f32 v[244:245], v[244:245], v[36:37]
  v_pk_mul_f32 v[246:247], v[246:247], v[38:39]
  v_cvt_pk_bf16_f32 v40, v240, v241
  v_cvt_pk_bf16_f32 v41, v242, v243
  v_cvt_pk_bf16_f32 v42, v244, v245
  v_cvt_pk_bf16_f32 v43, v246, v247
  buffer_store_dwordx4 v[40:43], v3, s[28:31], s34 offen offset:3072 sc1
  s_add_u32 s44, s44, 4096
  s_waitcnt vmcnt(15)
  s_branch .Lrecurr_dn29
.Lrecurr_noup20:
  s_mul_i32 s17, s16, 17408
  v_lshrrev_b32 v20, 3, v2
  v_and_b32 v21, 7, v2
  v_lshlrev_b32 v22, 1, v20
  v_and_b32 v22, 4, v22
  v_xor_b32 v22, v22, v21
  v_lshlrev_b32 v22, 4, v22
  v_lshl_add_u32 v104, v20, 10, v22
  v_add_u32 v105, 7168, v104
  v_add_u32 v106, 114688, v3
  v_add_u32 v107, 32768, v3
  v_lshlrev_b32 v14, 4, v21
  v_lshl_add_u32 v14, v20, 10, v14
  v_mul_u32_u24 v11, 1088, v21
  v_lshl_add_u32 v11, v20, 4, v11
  s_lshr_b32 s48, s16, 1
  s_mul_i32 s48, s48, 8704
  s_and_b32 s49, s16, 1
  s_lshl_b32 s49, s49, 8
  s_add_u32 s48, s48, s49
  v_add_u32 v11, s48, v11
  v_min_u32 v15, 6, v21
  v_lshlrev_b32 v15, 7, v15
  v_lshrrev_b32 v22, 5, v2
  v_bfe_u32 v23, v2, 2, 2
  v_lshl_add_u32 v22, v22, 2, v23
  v_lshlrev_b32 v22, 7, v22
  v_and_b32 v20, 1, v2
  v_lshl_add_u32 v22, v20, 3, v22
  v_add_u32 v22, s17, v22
  v_bfe_u32 v20, v2, 4, 1
  v_bfe_u32 v21, v2, 1, 1
  v_lshl_add_u32 v21, v20, 1, v21
  v_lshlrev_b32 v23, 1, v23
  v_and_b32 v23, 4, v23
  v_xor_b32 v21, v21, v23
  v_lshl_add_u32 v108, v21, 4, v22
  v_xor_b32 v21, 4, v21
  v_lshl_add_u32 v109, v21, 4, v22
  v_add_u32 v10, s17, v3
  v_mov_b32 v12, 0xc0135761
  v_mov_b32 v13, 0xc0135761
  s_and_b32 s14, s3, 7
  s_lshl_b32 s14, s14, 2
  s_lshr_b32 s15, s3, 6
  s_add_u32 s14, s14, s15
  s_bfe_u32 s15, s3, 0x30003
  s_mul_i32 s18, s16, 458752
  s_lshl_b32 s20, s15, 7
  s_add_u32 s18, s18, s20
  s_lshl_b32 s22, s16, 17
  s_add_u32 s22, s22, s20
  s_mov_b32 s24, s52
  s_mov_b32 s25, s53
  s_mov_b32 s26, 0x1c0000
  s_mov_b32 s27, 0x20000
  s_mov_b32 s4, s10
  s_mov_b32 s5, s11
  s_mov_b32 s6, 0x80000
  s_mov_b32 s7, 0x20000
  s_mul_i32 s19, s14, 229376
  s_mul_i32 s21, s16, 28672
  s_add_u32 s19, s19, s21
  s_add_u32 s19, s19, 0x500000
  s_lshl_b32 s23, s14, 16
  s_lshl_b32 s21, s16, 13
  s_add_u32 s23, s23, s21
  s_add_u32 s23, s23, 0xc00000
  s_lshl_b32 s46, s14, 16
  s_lshl_b32 s21, s16, 14
  s_add_u32 s46, s46, s21
  s_add_u32 s46, s46, s20
  s_add_u32 s47, s46, 8192
  s_lshl_b32 s53, s14, 12
  s_add_u32 s53, s53, 0xe40000
  s_lshl_b32 s52, s14, 13
  s_mul_i32 s21, s16, 896
  s_add_u32 s52, s52, s21
  s_add_u32 s52, s52, 0xf00000
  s_add_u32 s33, s52, 4096
  s_add_u32 m0, s17, 0
  s_nop 0
  buffer_load_dwordx4 v104, s[4:7], s22 offen lds
  buffer_load_dwordx4 v105, s[4:7], s22 offen offset:1024 lds
  s_add_u32 s22, s22, 0x4000
  s_add_u32 m0, s17, 2048
  s_nop 0
  buffer_load_dwordx4 v104, s[4:7], s22 offen lds
  buffer_load_dwordx4 v105, s[4:7], s22 offen offset:1024 lds
  s_add_u32 s22, s22, 0x4000
  s_add_u32 m0, s17, 4096
  s_nop 0
  buffer_load_dwordx4 v104, s[4:7], s22 offen lds
  buffer_load_dwordx4 v105, s[4:7], s22 offen offset:1024 lds
  s_add_u32 s22, s22, 0x4000
  s_add_u32 m0, s17, 6144
  s_nop 0
  buffer_load_dwordx4 v104, s[4:7], s22 offen lds
  buffer_load_dwordx4 v105, s[4:7], s22 offen offset:1024 lds
  s_add_u32 s22, s22, 0x4000
  s_add_u32 m0, s17, 8192
  s_nop 0
  buffer_load_dwordx4 v104, s[4:7], s22 offen lds
  buffer_load_dwordx4 v105, s[4:7], s22 offen offset:1024 lds
  s_add_u32 s22, s22, 0x4000
  s_add_u32 m0, s17, 10240
  s_nop 0
  buffer_load_dwordx4 v104, s[4:7], s22 offen lds
  buffer_load_dwordx4 v105, s[4:7], s22 offen offset:1024 lds
  s_add_u32 s22, s22, 0x4000
  s_add_u32 m0, s17, 12288
  s_nop 0
  buffer_load_dwordx4 v104, s[4:7], s22 offen lds
  buffer_load_dwordx4 v105, s[4:7], s22 offen offset:1024 lds
  s_add_u32 s22, s22, 0x4000
  s_add_u32 m0, s17, 14336
  s_nop 0
  buffer_load_dwordx4 v104, s[4:7], s22 offen lds
  buffer_load_dwordx4 v105, s[4:7], s22 offen offset:1024 lds
  s_add_u32 s22, s22, 0x4000
  s_waitcnt vmcnt(0)
  s_barrier
  v_readfirstlane_b32 s56, v92
  v_readfirstlane_b32 s57, v93
  s_mul_i32 s58, s56, 1664525
  s_add_u32 s58, s58, 1013904223
  s_mul_i32 s59, s57, 22695477
  s_add_u32 s59, s59, 0x3c6ef35f
  s_cmp_lg_u32 s16, 0
  s_cbranch_scc1 .Lrecurr_hl30
  s_lshl_b32 s50, s3, 3
  s_add_u32 s50, s50, 0xe70000
  v_mov_b32 v92, s58
  v_mov_b32 v93, s59
  v_lshlrev_b32 v94, 3, v2
  s_mov_b64 exec, 1
  buffer_store_dwordx2 v[92:93], v94, s[28:31], s50 offen sc1
  s_mov_b64 exec, -1
.Lrecurr_hl30:
  ds_read_b64_tr_b16 v[128:129], v108 offset:0
  ds_read_b64_tr_b16 v[130:131], v108 offset:1024
  ds_read_b64_tr_b16 v[132:133], v109 offset:0
  ds_read_b64_tr_b16 v[134:135], v109 offset:1024
  ds_read_b64_tr_b16 v[136:137], v108 offset:2048
  ds_read_b64_tr_b16 v[138:139], v108 offset:3072
  ds_read_b64_tr_b16 v[140:141], v109 offset:2048
  ds_read_b64_tr_b16 v[142:143], v109 offset:3072
  ds_read_b64_tr_b16 v[144:145], v108 offset:4096
  ds_read_b64_tr_b16 v[146:147], v108 offset:5120
  ds_read_b64_tr_b16 v[148:149], v109 offset:4096
  ds_read_b64_tr_b16 v[150:151], v109 offset:5120
  ds_read_b64_tr_b16 v[152:153], v108 offset:6144
  ds_read_b64_tr_b16 v[154:155], v108 offset:7168
  ds_read_b64_tr_b16 v[156:157], v109 offset:6144
  ds_read_b64_tr_b16 v[158:159], v109 offset:7168
  ds_read_b64_tr_b16 v[160:161], v108 offset:8192
  ds_read_b64_tr_b16 v[162:163], v108 offset:9216
  ds_read_b64_tr_b16 v[164:165], v109 offset:8192
  ds_read_b64_tr_b16 v[166:167], v109 offset:9216
  ds_read_b64_tr_b16 v[168:169], v108 offset:10240
  ds_read_b64_tr_b16 v[170:171], v108 offset:11264
  ds_read_b64_tr_b16 v[172:173], v109 offset:10240
  ds_read_b64_tr_b16 v[174:175], v109 offset:11264
  ds_read_b64_tr_b16 v[176:177], v108 offset:12288
  ds_read_b64_tr_b16 v[178:179], v108 offset:13312
  ds_read_b64_tr_b16 v[180:181], v109 offset:12288
  ds_read_b64_tr_b16 v[182:183], v109 offset:13312
  ds_read_b64_tr_b16 v[184:185], v108 offset:14336
  ds_read_b64_tr_b16 v[186:187], v108 offset:15360
  ds_read_b64_tr_b16 v[188:189], v109 offset:14336
  ds_read_b64_tr_b16 v[190:191], v109 offset:15360
  s_waitcnt lgkmcnt(0)
  s_add_u32 m0, s17, 0
  s_nop 0
  buffer_load_dwordx4 v104, s[24:27], s18 offen lds
  buffer_load_dwordx4 v105, s[24:27], s18 offen offset:1024 lds
  s_add_u32 s18, s18, 0x4000
  s_add_u32 m0, s17, 2048
  s_nop 0
  buffer_load_dwordx4 v104, s[24:27], s18 offen lds
  buffer_load_dwordx4 v105, s[24:27], s18 offen offset:1024 lds
  s_add_u32 s18, s18, 0xc000
  s_add_u32 m0, s17, 4096
  s_nop 0
  buffer_load_dwordx4 v104, s[24:27], s18 offen lds
  buffer_load_dwordx4 v105, s[24:27], s18 offen offset:1024 lds
  s_add_u32 s18, s18, 0x4000
  s_add_u32 m0, s17, 6144
  s_nop 0
  buffer_load_dwordx4 v104, s[24:27], s18 offen lds
  buffer_load_dwordx4 v105, s[24:27], s18 offen offset:1024 lds
  s_add_u32 s18, s18, 0xc000
  s_add_u32 m0, s17, 8192
  s_nop 0
  buffer_load_dwordx4 v104, s[24:27], s18 offen lds
  buffer_load_dwordx4 v105, s[24:27], s18 offen offset:1024 lds
  s_add_u32 s18, s18, 0x4000
  s_add_u32 m0, s17, 10240
  s_nop 0
  buffer_load_dwordx4 v104, s[24:27], s18 offen lds
  buffer_load_dwordx4 v105, s[24:27], s18 offen offset:1024 lds
  s_add_u32 s18, s18, 0xc000
  s_add_u32 m0, s17, 12288
  s_nop 0
  buffer_load_dwordx4 v104, s[24:27], s18 offen lds
  buffer_load_dwordx4 v105, s[24:27], s18 offen offset:1024 lds
  s_add_u32 s18, s18, 0x4000
  v_lshlrev_b32 v126, 7, v2
  s_bfe_u32 s21, s3, 0x20003
  s_lshl_b32 s21, s21, 2
  s_add_u32 s21, s21, s16
  s_mul_i32 s48, s21, 114688
  s_lshl_b32 s49, s21, 15
  s_mov_b32 s21, 14
.Lrecurr_tc31:
  buffer_load_dword v124, v126, s[24:27], s48 offen
  s_add_u32 s48, s48, 8192
  s_cmp_gt_u32 s21, 4
  s_cbranch_scc1 .Ltc2
  buffer_load_dword v125, v126, s[4:7], s49 offen
  s_add_u32 s49, s49, 8192
.Ltc2:
  s_waitcnt vmcnt(0)
  s_sub_u32 s21, s21, 1
  s_cmp_lg_u32 s21, 0
  s_cbranch_scc1 .Lrecurr_tc31
  v_mov_b32 v4, 0
  v_not_b32 v5, s59
.Lrecurr_dn29:
  s_mov_b32 s40, s54
  s_mov_b32 s41, s55
  s_mov_b32 s42, 0x200000
  s_mov_b32 s43, 0x20000
  s_setprio 0
  s_setprio 3
  v_cmp_eq_u64 vcc, s[58:59], v[4:5]
  s_cmp_eq_u64 vcc, -1
  s_cbranch_scc1 .Lrecurr_hf32
  s_cmp_ge_u32 s3, 224
  s_cbranch_scc1 .Lrecurr_hn34
  v_mov_b32 v6, s58
  v_mov_b32 v7, s59
  v_lshlrev_b32 v8, 3, v2
  s_waitcnt vmcnt(0)
  s_mov_b64 exec, 65535
  buffer_store_dwordx2 v[6:7], v8, s[28:31], s44 offen sc1
  s_mov_b64 exec, -1
.Lrecurr_hn34:
  s_mov_b32 s60, 0x40000
.Lrecurr_hp35:
  v_cmp_eq_u64 vcc, s[58:59], v[4:5]
  s_cmp_eq_u64 vcc, -1
  s_cbranch_scc1 .Lrecurr_hpd36
  s_sleep 4
  buffer_load_dwordx2 v[4:5], v15, s[28:31], s52 offen sc1
  s_waitcnt vmcnt(0)
  s_sub_u32 s60, s60, 1
  s_cmp_lg_u32 s60, 0
  s_cbranch_scc1 .Lrecurr_hp35
.Lrecurr_hpd36:
  buffer_load_dwordx4 v[32:35], v3, s[28:31], s19 offen sc1
  buffer_load_dwordx4 v[36:39], v106, s[28:31], s19 offen sc1
  s_add_u32 s19, s19, 0x400
  buffer_load_dwordx4 v[40:43], v3, s[28:31], s19 offen sc1
  buffer_load_dwordx4 v[44:47], v106, s[28:31], s19 offen sc1
  s_add_u32 s19, s19, 0xc00
  buffer_load_dwordx4 v[48:51], v3, s[28:31], s19 offen sc1
  buffer_load_dwordx4 v[52:55], v106, s[28:31], s19 offen sc1
  s_add_u32 s19, s19, 0x400
  buffer_load_dwordx4 v[56:59], v3, s[28:31], s19 offen sc1
  buffer_load_dwordx4 v[60:63], v106, s[28:31], s19 offen sc1
  s_add_u32 s19, s19, 0xc00
  buffer_load_dwordx4 v[64:67], v3, s[28:31], s19 offen sc1
  buffer_load_dwordx4 v[68:71], v106, s[28:31], s19 offen sc1
  s_add_u32 s19, s19, 0x400
  buffer_load_dwordx4 v[72:75], v3, s[28:31], s19 offen sc1
  buffer_load_dwordx4 v[76:79], v106, s[28:31], s19 offen sc1
  s_add_u32 s19, s19, 0xc00
  buffer_load_dwordx4 v[80:83], v3, s[28:31], s19 offen sc1
  buffer_load_dwordx4 v[84:87], v106, s[28:31], s19 offen sc1
  s_add_u32 s19, s19, 0x400
  s_branch .Lrecurr_hj33
.Lrecurr_hf32:
  buffer_load_dwordx4 v[32:35], v3, s[28:31], s19 offen sc1
  buffer_load_dwordx4 v[36:39], v106, s[28:31], s19 offen sc1
  s_add_u32 s19, s19, 0x400
  buffer_load_dwordx4 v[40:43], v3, s[28:31], s19 offen sc1
  buffer_load_dwordx4 v[44:47], v106, s[28:31], s19 offen sc1
  s_add_u32 s19, s19, 0xc00
  buffer_load_dwordx4 v[48:51], v3, s[28:31], s19 offen sc1
  buffer_load_dwordx4 v[52:55], v106, s[28:31], s19 offen sc1
  s_add_u32 s19, s19, 0x400
  buffer_load_dwordx4 v[56:59], v3, s[28:31], s19 offen sc1
  buffer_load_dwordx4 v[60:63], v106, s[28:31], s19 offen sc1
  s_add_u32 s19, s19, 0xc00
  buffer_load_dwordx4 v[64:67], v3, s[28:31], s19 offen sc1
  buffer_load_dwordx4 v[68:71], v106, s[28:31], s19 offen sc1
  s_add_u32 s19, s19, 0x400
  buffer_load_dwordx4 v[72:75], v3, s[28:31], s19 offen sc1
  buffer_load_dwordx4 v[76:79], v106, s[28:31], s19 offen sc1
  s_add_u32 s19, s19, 0xc00
  buffer_load_dwordx4 v[80:83], v3, s[28:31], s19 offen sc1
  buffer_load_dwordx4 v[84:87], v106, s[28:31], s19 offen sc1
  s_add_u32 s19, s19, 0x400
  v_mov_b32 v6, s58
  v_mov_b32 v7, s59
  v_lshlrev_b32 v8, 3, v2
  s_waitcnt vmcnt(14)
  s_mov_b64 exec, 65535
  buffer_store_dwordx2 v[6:7], v8, s[28:31], s44 offen sc1
  s_mov_b64 exec, -1
.Lrecurr_hj33:
  s_setprio 0
  buffer_load_dwordx4 v[96:99], v14, s[36:39], s46 offen
  buffer_load_dwordx4 v[100:103], v14, s[36:39], s47 offen
  s_waitcnt vmcnt(28)
  ds_read_b64_tr_b16 v[16:17], v108 offset:0
  ds_read_b64_tr_b16 v[18:19], v108 offset:1024
  ds_read_b64_tr_b16 v[20:21], v109 offset:0
  ds_read_b64_tr_b16 v[22:23], v109 offset:1024
  s_waitcnt vmcnt(14) lgkmcnt(0)
  ds_read_b64_tr_b16 v[24:25], v108 offset:2048
  ds_read_b64_tr_b16 v[26:27], v108 offset:3072
  ds_read_b64_tr_b16 v[28:29], v109 offset:2048
  ds_read_b64_tr_b16 v[30:31], v109 offset:3072
  v_mfma_f32_32x32x16_bf16 v[192:207], v[16:19], v[32:35], 0
  v_mfma_f32_32x32x16_bf16 v[208:223], v[20:23], v[32:35], 0
  v_mfma_f32_32x32x16_bf16 v[224:239], v[16:19], v[36:39], 0
  v_mfma_f32_32x32x16_bf16 v[240:255], v[20:23], v[36:39], 0
  s_add_u32 m0, s17, 0
  s_nop 0
  buffer_load_dwordx4 v104, s[24:27], s18 offen lds
  buffer_load_dwordx4 v105, s[24:27], s18 offen offset:1024 lds
  s_add_u32 s18, s18, 0xc000
  buffer_load_dwordx4 v[32:35], v3, s[28:31], s19 offen sc1
  buffer_load_dwordx4 v[36:39], v106, s[28:31], s19 offen sc1
  s_add_u32 s19, s19, 0xc00
  s_waitcnt vmcnt(16) lgkmcnt(0)
  ds_read_b64_tr_b16 v[16:17], v108 offset:4096
  ds_read_b64_tr_b16 v[18:19], v108 offset:5120
  ds_read_b64_tr_b16 v[20:21], v109 offset:4096
  ds_read_b64_tr_b16 v[22:23], v109 offset:5120
  v_mfma_f32_32x32x16_bf16 v[192:207], v[24:27], v[40:43], v[192:207]
  v_mfma_f32_32x32x16_bf16 v[208:223], v[28:31], v[40:43], v[208:223]
  v_mfma_f32_32x32x16_bf16 v[224:239], v[24:27], v[44:47], v[224:239]
  v_mfma_f32_32x32x16_bf16 v[240:255], v[28:31], v[44:47], v[240:255]
  s_add_u32 m0, s17, 2048
  s_nop 0
  buffer_load_dwordx4 v104, s[24:27], s18 offen lds
  buffer_load_dwordx4 v105, s[24:27], s18 offen offset:1024 lds
  s_add_u32 s18, s18, 0x4000
  buffer_load_dwordx4 v[40:43], v3, s[28:31], s19 offen sc1
  buffer_load_dwordx4 v[44:47], v106, s[28:31], s19 offen sc1
  s_add_u32 s19, s19, 0x400
  s_waitcnt vmcnt(18) lgkmcnt(0)
  ds_read_b64_tr_b16 v[24:25], v108 offset:6144
  ds_read_b64_tr_b16 v[26:27], v108 offset:7168
  ds_read_b64_tr_b16 v[28:29], v109 offset:6144
  ds_read_b64_tr_b16 v[30:31], v109 offset:7168
  v_mfma_f32_32x32x16_bf16 v[192:207], v[16:19], v[48:51], v[192:207]
  v_mfma_f32_32x32x16_bf16 v[208:223], v[20:23], v[48:51], v[208:223]
  v_mfma_f32_32x32x16_bf16 v[224:239], v[16:19], v[52:55], v[224:239]
  v_mfma_f32_32x32x16_bf16 v[240:255], v[20:23], v[52:55], v[240:255]
  s_add_u32 m0, s17, 4096
  s_nop 0
  buffer_load_dwordx4 v104, s[24:27], s18 offen lds
  buffer_load_dwordx4 v105, s[24:27], s18 offen offset:1024 lds
  s_add_u32 s18, s18, 0xc000
  buffer_load_dwordx4 v[48:51], v3, s[28:31], s19 offen sc1
  buffer_load_dwordx4 v[52:55], v106, s[28:31], s19 offen sc1
  s_add_u32 s19, s19, 0xc00
  s_waitcnt vmcnt(20) lgkmcnt(0)
  ds_read_b64_tr_b16 v[16:17], v108 offset:8192
  ds_read_b64_tr_b16 v[18:19], v108 offset:9216
  ds_read_b64_tr_b16 v[20:21], v109 offset:8192
  ds_read_b64_tr_b16 v[22:23], v109 offset:9216
  v_mfma_f32_32x32x16_bf16 v[192:207], v[24:27], v[56:59], v[192:207]
  v_mfma_f32_32x32x16_bf16 v[208:223], v[28:31], v[56:59], v[208:223]
  v_mfma_f32_32x32x16_bf16 v[224:239], v[24:27], v[60:63], v[224:239]
  v_mfma_f32_32x32x16_bf16 v[240:255], v[28:31], v[60:63], v[240:255]
  buffer_load_dwordx2 v[4:5], v15, s[28:31], s33 offen sc1
  s_add_u32 m0, s17, 6144
  s_nop 0
  buffer_load_dwordx4 v104, s[24:27], s18 offen lds
  buffer_load_dwordx4 v105, s[24:27], s18 offen offset:1024 lds
  s_add_u32 s18, s18, 0x4000
  buffer_load_dwordx4 v[56:59], v3, s[28:31], s19 offen sc1
  buffer_load_dwordx4 v[60:63], v106, s[28:31], s19 offen sc1
  s_add_u32 s19, s19, 0x400
  s_waitcnt vmcnt(23) lgkmcnt(0)
  ds_read_b64_tr_b16 v[24:25], v108 offset:10240
  ds_read_b64_tr_b16 v[26:27], v108 offset:11264
  ds_read_b64_tr_b16 v[28:29], v109 offset:10240
  ds_read_b64_tr_b16 v[30:31], v109 offset:11264
  v_mfma_f32_32x32x16_bf16 v[192:207], v[16:19], v[64:67], v[192:207]
  v_mfma_f32_32x32x16_bf16 v[208:223], v[20:23], v[64:67], v[208:223]
  v_mfma_f32_32x32x16_bf16 v[224:239], v[16:19], v[68:71], v[224:239]
  v_mfma_f32_32x32x16_bf16 v[240:255], v[20:23], v[68:71], v[240:255]
  s_add_u32 m0, s17, 8192
  s_nop 0
  buffer_load_dwordx4 v104, s[24:27], s18 offen lds
  buffer_load_dwordx4 v105, s[24:27], s18 offen offset:1024 lds
  s_add_u32 s18, s18, 0xc000
  buffer_load_dwordx4 v[64:67], v3, s[28:31], s19 offen sc1
  buffer_load_dwordx4 v[68:71], v106, s[28:31], s19 offen sc1
  s_add_u32 s19, s19, 0xc00
  s_waitcnt vmcnt(25) lgkmcnt(0)
  ds_read_b64_tr_b16 v[16:17], v108 offset:12288
  ds_read_b64_tr_b16 v[18:19], v108 offset:13312
  ds_read_b64_tr_b16 v[20:21], v109 offset:12288
  ds_read_b64_tr_b16 v[22:23], v109 offset:13312
  v_mfma_f32_32x32x16_bf16 v[192:207], v[24:27], v[72:75], v[192:207]
  v_mfma_f32_32x32x16_bf16 v[208:223], v[28:31], v[72:75], v[208:223]
  v_mfma_f32_32x32x16_bf16 v[224:239], v[24:27], v[76:79], v[224:239]
  v_mfma_f32_32x32x16_bf16 v[240:255], v[28:31], v[76:79], v[240:255]
  s_add_u32 m0, s17, 10240
  s_nop 0
  buffer_load_dwordx4 v104, s[24:27], s18 offen lds
  buffer_load_dwordx4 v105, s[24:27], s18 offen offset:1024 lds
  s_add_u32 s18, s18, 0x4000
  buffer_load_dwordx4 v[72:75], v3, s[28:31], s19 offen sc1
  buffer_load_dwordx4 v[76:79], v106, s[28:31], s19 offen sc1
  s_add_u32 s19, s19, 0x400
  s_waitcnt vmcnt(23) lgkmcnt(0)
  ds_read_b64_tr_b16 v[24:25], v108 offset:0
  ds_read_b64_tr_b16 v[26:27], v108 offset:1024
  ds_read_b64_tr_b16 v[28:29], v109 offset:0
  ds_read_b64_tr_b16 v[30:31], v109 offset:1024
  v_mfma_f32_32x32x16_bf16 v[192:207], v[16:19], v[80:83], v[192:207]
  v_mfma_f32_32x32x16_bf16 v[208:223], v[20:23], v[80:83], v[208:223]
  v_mfma_f32_32x32x16_bf16 v[224:239], v[16:19], v[84:87], v[224:239]
  v_mfma_f32_32x32x16_bf16 v[240:255], v[20:23], v[84:87], v[240:255]
  s_add_u32 m0, s17, 12288
  s_nop 0
  buffer_load_dwordx4 v104, s[24:27], s18 offen lds
  buffer_load_dwordx4 v105, s[24:27], s18 offen offset:1024 lds
  s_add_u32 s18, s18, 0xfffa4000
  buffer_load_dwordx4 v[80:83], v3, s[28:31], s19 offen sc1
  buffer_load_dwordx4 v[84:87], v106, s[28:31], s19 offen sc1
  s_add_u32 s19, s19, 0xffffa400
  s_waitcnt vmcnt(23) lgkmcnt(0)
  ds_read_b64_tr_b16 v[16:17], v108 offset:2048
  ds_read_b64_tr_b16 v[18:19], v108 offset:3072
  ds_read_b64_tr_b16 v[20:21], v109 offset:2048
  ds_read_b64_tr_b16 v[22:23], v109 offset:3072
  v_mfma_f32_32x32x16_bf16 v[192:207], v[24:27], v[32:35], v[192:207]
  v_mfma_f32_32x32x16_bf16 v[208:223], v[28:31], v[32:35], v[208:223]
  v_mfma_f32_32x32x16_bf16 v[224:239], v[24:27], v[36:39], v[224:239]
  v_mfma_f32_32x32x16_bf16 v[240:255], v[28:31], v[36:39], v[240:255]
  s_add_u32 m0, s17, 0
  s_nop 0
  buffer_load_dwordx4 v104, s[24:27], s18 offen lds
  buffer_load_dwordx4 v105, s[24:27], s18 offen offset:1024 lds
  s_add_u32 s18, s18, 0x4000
  s_waitcnt vmcnt(18)
  s_setprio 3
  s_mov_b32 s60, 0x40000
.Lrecurr_hp37:
  v_cmp_eq_u64 vcc, s[58:59], v[4:5]
  s_cmp_eq_u64 vcc, -1
  s_cbranch_scc1 .Lrecurr_hpd38
  s_sleep 2
  buffer_load_dwordx2 v[4:5], v15, s[28:31], s33 offen sc1
  s_waitcnt vmcnt(0)
  s_sub_u32 s60, s60, 1
  s_cmp_lg_u32 s60, 0
  s_cbranch_scc1 .Lrecurr_hp37
.Lrecurr_hpd38:
  s_setprio 0
  buffer_load_dwordx4 v[32:35], v3, s[28:31], s19 offen sc1
  buffer_load_dwordx4 v[36:39], v106, s[28:31], s19 offen sc1
  s_add_u32 s19, s19, 0x400
  s_waitcnt lgkmcnt(0)
  ds_read_b64_tr_b16 v[24:25], v108 offset:4096
  ds_read_b64_tr_b16 v[26:27], v108 offset:5120
  ds_read_b64_tr_b16 v[28:29], v109 offset:4096
  ds_read_b64_tr_b16 v[30:31], v109 offset:5120
  v_mfma_f32_32x32x16_bf16 v[192:207], v[16:19], v[40:43], v[192:207]
  v_mfma_f32_32x32x16_bf16 v[208:223], v[20:23], v[40:43], v[208:223]
  v_mfma_f32_32x32x16_bf16 v[224:239], v[16:19], v[44:47], v[224:239]
  v_mfma_f32_32x32x16_bf16 v[240:255], v[20:23], v[44:47], v[240:255]
  s_add_u32 m0, s17, 2048
  s_nop 0
  buffer_load_dwordx4 v104, s[24:27], s18 offen lds
  buffer_load_dwordx4 v105, s[24:27], s18 offen offset:1024 lds
  s_add_u32 s18, s18, 0xc000
  buffer_load_dwordx4 v[40:43], v3, s[28:31], s19 offen sc1
  buffer_load_dwordx4 v[44:47], v106, s[28:31], s19 offen sc1
  s_add_u32 s19, s19, 0xc00
  s_waitcnt vmcnt(22) lgkmcnt(0)
  ds_read_b64_tr_b16 v[16:17], v108 offset:6144
  ds_read_b64_tr_b16 v[18:19], v108 offset:7168
  ds_read_b64_tr_b16 v[20:21], v109 offset:6144
  ds_read_b64_tr_b16 v[22:23], v109 offset:7168
  v_mfma_f32_32x32x16_bf16 v[192:207], v[24:27], v[48:51], v[192:207]
  v_mfma_f32_32x32x16_bf16 v[208:223], v[28:31], v[48:51], v[208:223]
  v_mfma_f32_32x32x16_bf16 v[224:239], v[24:27], v[52:55], v[224:239]
  v_mfma_f32_32x32x16_bf16 v[240:255], v[28:31], v[52:55], v[240:255]
  s_add_u32 m0, s17, 4096
  s_nop 0
  buffer_load_dwordx4 v104, s[24:27], s18 offen lds
  buffer_load_dwordx4 v105, s[24:27], s18 offen offset:1024 lds
  s_add_u32 s18, s18, 0x4000
  buffer_load_dwordx4 v[48:51], v3, s[28:31], s19 offen sc1
  buffer_load_dwordx4 v[52:55], v106, s[28:31], s19 offen sc1
  s_add_u32 s19, s19, 0x400
  s_waitcnt vmcnt(22) lgkmcnt(0)
  ds_read_b64_tr_b16 v[24:25], v108 offset:8192
  ds_read_b64_tr_b16 v[26:27], v108 offset:9216
  ds_read_b64_tr_b16 v[28:29], v109 offset:8192
  ds_read_b64_tr_b16 v[30:31], v109 offset:9216
  v_mfma_f32_32x32x16_bf16 v[192:207], v[16:19], v[56:59], v[192:207]
  v_mfma_f32_32x32x16_bf16 v[208:223], v[20:23], v[56:59], v[208:223]
  v_mfma_f32_32x32x16_bf16 v[224:239], v[16:19], v[60:63], v[224:239]
  v_mfma_f32_32x32x16_bf16 v[240:255], v[20:23], v[60:63], v[240:255]
  s_add_u32 m0, s17, 6144
  s_nop 0
  buffer_load_dwordx4 v104, s[24:27], s18 offen lds
  buffer_load_dwordx4 v105, s[24:27], s18 offen offset:1024 lds
  s_add_u32 s18, s18, 0xc000
  buffer_load_dwordx4 v[56:59], v3, s[28:31], s19 offen sc1
  buffer_load_dwordx4 v[60:63], v106, s[28:31], s19 offen sc1
  s_add_u32 s19, s19, 0xc00
  s_waitcnt vmcnt(22) lgkmcnt(0)
  ds_read_b64_tr_b16 v[16:17], v108 offset:10240
  ds_read_b64_tr_b16 v[18:19], v108 offset:11264
  ds_read_b64_tr_b16 v[20:21], v109 offset:10240
  ds_read_b64_tr_b16 v[22:23], v109 offset:11264
  v_mfma_f32_32x32x16_bf16 v[192:207], v[24:27], v[64:67], v[192:207]
  v_mfma_f32_32x32x16_bf16 v[208:223], v[28:31], v[64:67], v[208:223]
  v_mfma_f32_32x32x16_bf16 v[224:239], v[24:27], v[68:71], v[224:239]
  v_mfma_f32_32x32x16_bf16 v[240:255], v[28:31], v[68:71], v[240:255]
  s_add_u32 m0, s17, 8192
  s_nop 0
  buffer_load_dwordx4 v104, s[24:27], s18 offen lds
  buffer_load_dwordx4 v105, s[24:27], s18 offen offset:1024 lds
  s_add_u32 s18, s18, 0x4000
  buffer_load_dwordx4 v[64:67], v3, s[28:31], s19 offen sc1
  buffer_load_dwordx4 v[68:71], v106, s[28:31], s19 offen sc1
  s_add_u32 s19, s19, 0x400
  s_waitcnt vmcnt(22) lgkmcnt(0)
  ds_read_b64_tr_b16 v[24:25], v108 offset:12288
  ds_read_b64_tr_b16 v[26:27], v108 offset:13312
  ds_read_b64_tr_b16 v[28:29], v109 offset:12288
  ds_read_b64_tr_b16 v[30:31], v109 offset:13312
  v_mfma_f32_32x32x16_bf16 v[192:207], v[16:19], v[72:75], v[192:207]
  v_mfma_f32_32x32x16_bf16 v[208:223], v[20:23], v[72:75], v[208:223]
  v_mfma_f32_32x32x16_bf16 v[224:239], v[16:19], v[76:79], v[224:239]
  v_mfma_f32_32x32x16_bf16 v[240:255], v[20:23], v[76:79], v[240:255]
  s_add_u32 m0, s17, 10240
  s_nop 0
  buffer_load_dwordx4 v104, s[24:27], s18 offen lds
  buffer_load_dwordx4 v105, s[24:27], s18 offen offset:1024 lds
  s_add_u32 s18, s18, 0xc000
  buffer_load_dwordx4 v[72:75], v3, s[28:31], s19 offen sc1
  buffer_load_dwordx4 v[76:79], v106, s[28:31], s19 offen sc1
  s_add_u32 s19, s19, 0xc00
  s_waitcnt vmcnt(22) lgkmcnt(0)
  ds_read_b64_tr_b16 v[16:17], v108 offset:0
  ds_read_b64_tr_b16 v[18:19], v108 offset:1024
  ds_read_b64_tr_b16 v[20:21], v109 offset:0
  ds_read_b64_tr_b16 v[22:23], v109 offset:1024
  v_mfma_f32_32x32x16_bf16 v[192:207], v[24:27], v[80:83], v[192:207]
  v_mfma_f32_32x32x16_bf16 v[208:223], v[28:31], v[80:83], v[208:223]
  v_mfma_f32_32x32x16_bf16 v[224:239], v[24:27], v[84:87], v[224:239]
  v_mfma_f32_32x32x16_bf16 v[240:255], v[28:31], v[84:87], v[240:255]
  s_add_u32 m0, s17, 12288
  s_nop 0
  buffer_load_dwordx4 v104, s[24:27], s18 offen lds
  buffer_load_dwordx4 v105, s[24:27], s18 offen offset:1024 lds
  s_add_u32 s18, s18, 0x4000
  buffer_load_dwordx4 v[80:83], v3, s[28:31], s19 offen sc1
  buffer_load_dwordx4 v[84:87], v106, s[28:31], s19 offen sc1
  s_add_u32 s19, s19, 0x400
  s_waitcnt vmcnt(22) lgkmcnt(0)
  ds_read_b64_tr_b16 v[24:25], v108 offset:2048
  ds_read_b64_tr_b16 v[26:27], v108 offset:3072
  ds_read_b64_tr_b16 v[28:29], v109 offset:2048
  ds_read_b64_tr_b16 v[30:31], v109 offset:3072
  v_mfma_f32_32x32x16_bf16 v[192:207], v[16:19], v[32:35], v[192:207]
  v_mfma_f32_32x32x16_bf16 v[208:223], v[20:23], v[32:35], v[208:223]
  v_mfma_f32_32x32x16_bf16 v[224:239], v[16:19], v[36:39], v[224:239]
  v_mfma_f32_32x32x16_bf16 v[240:255], v[20:23], v[36:39], v[240:255]
  s_add_u32 m0, s17, 0
  s_nop 0
  buffer_load_dwordx4 v104, s[24:27], s18 offen lds
  buffer_load_dwordx4 v105, s[24:27], s18 offen offset:1024 lds
  s_add_u32 s18, s18, 0xc000
  buffer_load_dwordx4 v[32:35], v3, s[28:31], s19 offen sc1
  buffer_load_dwordx4 v[36:39], v106, s[28:31], s19 offen sc1
  s_add_u32 s19, s19, 0xc00
  s_waitcnt vmcnt(22) lgkmcnt(0)
  ds_read_b64_tr_b16 v[16:17], v108 offset:4096
  ds_read_b64_tr_b16 v[18:19], v108 offset:5120
  ds_read_b64_tr_b16 v[20:21], v109 offset:4096
  ds_read_b64_tr_b16 v[22:23], v109 offset:5120
  v_mfma_f32_32x32x16_bf16 v[192:207], v[24:27], v[40:43], v[192:207]
  v_mfma_f32_32x32x16_bf16 v[208:223], v[28:31], v[40:43], v[208:223]
  v_mfma_f32_32x32x16_bf16 v[224:239], v[24:27], v[44:47], v[224:239]
  v_mfma_f32_32x32x16_bf16 v[240:255], v[28:31], v[44:47], v[240:255]
  s_add_u32 m0, s17, 2048
  s_nop 0
  buffer_load_dwordx4 v104, s[24:27], s18 offen lds
  buffer_load_dwordx4 v105, s[24:27], s18 offen offset:1024 lds
  s_add_u32 s18, s18, 0x4000
  buffer_load_dwordx4 v[40:43], v3, s[28:31], s19 offen sc1
  buffer_load_dwordx4 v[44:47], v106, s[28:31], s19 offen sc1
  s_add_u32 s19, s19, 0x400
  s_waitcnt vmcnt(22) lgkmcnt(0)
  ds_read_b64_tr_b16 v[24:25], v108 offset:6144
  ds_read_b64_tr_b16 v[26:27], v108 offset:7168
  ds_read_b64_tr_b16 v[28:29], v109 offset:6144
  ds_read_b64_tr_b16 v[30:31], v109 offset:7168
  v_mfma_f32_32x32x16_bf16 v[192:207], v[16:19], v[48:51], v[192:207]
  v_mfma_f32_32x32x16_bf16 v[208:223], v[20:23], v[48:51], v[208:223]
  v_mfma_f32_32x32x16_bf16 v[224:239], v[16:19], v[52:55], v[224:239]
  v_mfma_f32_32x32x16_bf16 v[240:255], v[20:23], v[52:55], v[240:255]
  s_add_u32 m0, s17, 4096
  s_nop 0
  buffer_load_dwordx4 v104, s[24:27], s18 offen lds
  buffer_load_dwordx4 v105, s[24:27], s18 offen offset:1024 lds
  s_add_u32 s18, s18, 0xc000
  buffer_load_dwordx4 v[48:51], v3, s[28:31], s19 offen sc1
  buffer_load_dwordx4 v[52:55], v106, s[28:31], s19 offen sc1
  s_add_u32 s19, s19, 0xc00
  s_waitcnt vmcnt(22) lgkmcnt(0)
  ds_read_b64_tr_b16 v[16:17], v108 offset:8192
  ds_read_b64_tr_b16 v[18:19], v108 offset:9216
  ds_read_b64_tr_b16 v[20:21], v109 offset:8192
  ds_read_b64_tr_b16 v[22:23], v109 offset:9216
  v_mfma_f32_32x32x16_bf16 v[192:207], v[24:27], v[56:59], v[192:207]
  v_mfma_f32_32x32x16_bf16 v[208:223], v[28:31], v[56:59], v[208:223]
  v_mfma_f32_32x32x16_bf16 v[224:239], v[24:27], v[60:63], v[224:239]
  v_mfma_f32_32x32x16_bf16 v[240:255], v[28:31], v[60:63], v[240:255]
  s_add_u32 m0, s17, 6144
  s_nop 0
  buffer_load_dwordx4 v104, s[24:27], s18 offen lds
  buffer_load_dwordx4 v105, s[24:27], s18 offen offset:1024 lds
  s_add_u32 s18, s18, 0x4000
  buffer_load_dwordx4 v[56:59], v3, s[28:31], s19 offen sc1
  buffer_load_dwordx4 v[60:63], v106, s[28:31], s19 offen sc1
  s_add_u32 s19, s19, 0x400
  s_waitcnt vmcnt(22) lgkmcnt(0)
  ds_read_b64_tr_b16 v[24:25], v108 offset:10240
  ds_read_b64_tr_b16 v[26:27], v108 offset:11264
  ds_read_b64_tr_b16 v[28:29], v109 offset:10240
  ds_read_b64_tr_b16 v[30:31], v109 offset:11264
  v_mfma_f32_32x32x16_bf16 v[192:207], v[16:19], v[64:67], v[192:207]
  v_mfma_f32_32x32x16_bf16 v[208:223], v[20:23], v[64:67], v[208:223]
  v_mfma_f32_32x32x16_bf16 v[224:239], v[16:19], v[68:71], v[224:239]
  v_mfma_f32_32x32x16_bf16 v[240:255], v[20:23], v[68:71], v[240:255]
  s_add_u32 m0, s17, 8192
  s_nop 0
  buffer_load_dwordx4 v104, s[24:27], s18 offen lds
  buffer_load_dwordx4 v105, s[24:27], s18 offen offset:1024 lds
  s_add_u32 s18, s18, 0xc000
  buffer_load_dwordx4 v[64:67], v3, s[28:31], s19 offen sc1
  buffer_load_dwordx4 v[68:71], v106, s[28:31], s19 offen sc1
  s_add_u32 s19, s19, 0xc00
  s_waitcnt vmcnt(22) lgkmcnt(0)
  ds_read_b64_tr_b16 v[16:17], v108 offset:12288
  ds_read_b64_tr_b16 v[18:19], v108 offset:13312
  ds_read_b64_tr_b16 v[20:21], v109 offset:12288
  ds_read_b64_tr_b16 v[22:23], v109 offset:13312
  v_mfma_f32_32x32x16_bf16 v[192:207], v[24:27], v[72:75], v[192:207]
  v_mfma_f32_32x32x16_bf16 v[208:223], v[28:31], v[72:75], v[208:223]
  v_mfma_f32_32x32x16_bf16 v[224:239], v[24:27], v[76:79], v[224:239]
  v_mfma_f32_32x32x16_bf16 v[240:255], v[28:31], v[76:79], v[240:255]
  s_add_u32 m0, s17, 10240
  s_nop 0
  buffer_load_dwordx4 v104, s[24:27], s18 offen lds
  buffer_load_dwordx4 v105, s[24:27], s18 offen offset:1024 lds
  s_add_u32 s18, s18, 0x4000
  buffer_load_dwordx4 v[72:75], v3, s[28:31], s19 offen sc1
  buffer_load_dwordx4 v[76:79], v106, s[28:31], s19 offen sc1
  s_add_u32 s19, s19, 0x400
  s_waitcnt vmcnt(22) lgkmcnt(0)
  ds_read_b64_tr_b16 v[24:25], v108 offset:0
  ds_read_b64_tr_b16 v[26:27], v108 offset:1024
  ds_read_b64_tr_b16 v[28:29], v109 offset:0
  ds_read_b64_tr_b16 v[30:31], v109 offset:1024
  v_mfma_f32_32x32x16_bf16 v[192:207], v[16:19], v[80:83], v[192:207]
  v_mfma_f32_32x32x16_bf16 v[208:223], v[20:23], v[80:83], v[208:223]
  v_mfma_f32_32x32x16_bf16 v[224:239], v[16:19], v[84:87], v[224:239]
  v_mfma_f32_32x32x16_bf16 v[240:255], v[20:23], v[84:87], v[240:255]
  s_add_u32 m0, s17, 12288
  s_nop 0
  buffer_load_dwordx4 v104, s[24:27], s18 offen lds
  buffer_load_dwordx4 v105, s[24:27], s18 offen offset:1024 lds
  s_add_u32 s18, s18, 0x0
  buffer_load_dwordx4 v[80:83], v3, s[28:31], s19 offen sc1
  buffer_load_dwordx4 v[84:87], v106, s[28:31], s19 offen sc1
  s_add_u32 s19, s19, 0x0
  s_waitcnt vmcnt(22) lgkmcnt(0)
  ds_read_b64_tr_b16 v[16:17], v108 offset:2048
  ds_read_b64_tr_b16 v[18:19], v108 offset:3072
  ds_read_b64_tr_b16 v[20:21], v109 offset:2048
  ds_read_b64_tr_b16 v[22:23], v109 offset:3072
  v_mfma_f32_32x32x16_bf16 v[192:207], v[24:27], v[32:35], v[192:207]
  v_mfma_f32_32x32x16_bf16 v[208:223], v[28:31], v[32:35], v[208:223]
  v_mfma_f32_32x32x16_bf16 v[224:239], v[24:27], v[36:39], v[224:239]
  v_mfma_f32_32x32x16_bf16 v[240:255], v[28:31], v[36:39], v[240:255]
  s_waitcnt vmcnt(18) lgkmcnt(0)
  ds_read_b64_tr_b16 v[24:25], v108 offset:4096
  ds_read_b64_tr_b16 v[26:27], v108 offset:5120
  ds_read_b64_tr_b16 v[28:29], v109 offset:4096
  ds_read_b64_tr_b16 v[30:31], v109 offset:5120
  v_mfma_f32_32x32x16_bf16 v[192:207], v[16:19], v[40:43], v[192:207]
  v_mfma_f32_32x32x16_bf16 v[208:223], v[20:23], v[40:43], v[208:223]
  v_mfma_f32_32x32x16_bf16 v[224:239], v[16:19], v[44:47], v[224:239]
  v_mfma_f32_32x32x16_bf16 v[240:255], v[20:23], v[44:47], v[240:255]
  s_waitcnt vmcnt(14) lgkmcnt(0)
  ds_read_b64_tr_b16 v[16:17], v108 offset:6144
  ds_read_b64_tr_b16 v[18:19], v108 offset:7168
  ds_read_b64_tr_b16 v[20:21], v109 offset:6144
  ds_read_b64_tr_b16 v[22:23], v109 offset:7168
  v_mfma_f32_32x32x16_bf16 v[192:207], v[24:27], v[48:51], v[192:207]
  v_mfma_f32_32x32x16_bf16 v[208:223], v[28:31], v[48:51], v[208:223]
  v_mfma_f32_32x32x16_bf16 v[224:239], v[24:27], v[52:55], v[224:239]
  v_mfma_f32_32x32x16_bf16 v[240:255], v[28:31], v[52:55], v[240:255]
  s_waitcnt vmcnt(10) lgkmcnt(0)
  ds_read_b64_tr_b16 v[24:25], v108 offset:8192
  ds_read_b64_tr_b16 v[26:27], v108 offset:9216
  ds_read_b64_tr_b16 v[28:29], v109 offset:8192
  ds_read_b64_tr_b16 v[30:31], v109 offset:9216
  v_mfma_f32_32x32x16_bf16 v[192:207], v[16:19], v[56:59], v[192:207]
  v_mfma_f32_32x32x16_bf16 v[208:223], v[20:23], v[56:59], v[208:223]
  v_mfma_f32_32x32x16_bf16 v[224:239], v[16:19], v[60:63], v[224:239]
  v_mfma_f32_32x32x16_bf16 v[240:255], v[20:23], v[60:63], v[240:255]
  s_waitcnt vmcnt(6) lgkmcnt(0)
  ds_read_b64_tr_b16 v[16:17], v108 offset:10240
  ds_read_b64_tr_b16 v[18:19], v108 offset:11264
  ds_read_b64_tr_b16 v[20:21], v109 offset:10240
  ds_read_b64_tr_b16 v[22:23], v109 offset:11264
  v_mfma_f32_32x32x16_bf16 v[192:207], v[24:27], v[64:67], v[192:207]
  v_mfma_f32_32x32x16_bf16 v[208:223], v[28:31], v[64:67], v[208:223]
  v_mfma_f32_32x32x16_bf16 v[224:239], v[24:27], v[68:71], v[224:239]
  v_mfma_f32_32x32x16_bf16 v[240:255], v[28:31], v[68:71], v[240:255]
  s_waitcnt vmcnt(2) lgkmcnt(0)
  ds_read_b64_tr_b16 v[24:25], v108 offset:12288
  ds_read_b64_tr_b16 v[26:27], v108 offset:13312
  ds_read_b64_tr_b16 v[28:29], v109 offset:12288
  ds_read_b64_tr_b16 v[30:31], v109 offset:13312
  v_mfma_f32_32x32x16_bf16 v[192:207], v[16:19], v[72:75], v[192:207]
  v_mfma_f32_32x32x16_bf16 v[208:223], v[20:23], v[72:75], v[208:223]
  v_mfma_f32_32x32x16_bf16 v[224:239], v[16:19], v[76:79], v[224:239]
  v_mfma_f32_32x32x16_bf16 v[240:255], v[20:23], v[76:79], v[240:255]
  s_waitcnt vmcnt(0) lgkmcnt(0)
  v_mfma_f32_32x32x16_bf16 v[192:207], v[24:27], v[80:83], v[192:207]
  v_mfma_f32_32x32x16_bf16 v[208:223], v[28:31], v[80:83], v[208:223]
  v_mfma_f32_32x32x16_bf16 v[224:239], v[24:27], v[84:87], v[224:239]
  v_mfma_f32_32x32x16_bf16 v[240:255], v[28:31], v[84:87], v[240:255]
  s_setprio 3
  s_nop 8
  ds_write_b128 v10, v[192:195] offset:0
  ds_write_b128 v10, v[196:199] offset:1088
  ds_write_b128 v10, v[200:203] offset:2176
  ds_write_b128 v10, v[204:207] offset:3264
  ds_write_b128 v10, v[208:211] offset:4352
  ds_write_b128 v10, v[212:215] offset:5440
  ds_write_b128 v10, v[216:219] offset:6528
  ds_write_b128 v10, v[220:223] offset:7616
  ds_write_b128 v10, v[224:227] offset:8704
  ds_write_b128 v10, v[228:231] offset:9792
  ds_write_b128 v10, v[232:235] offset:10880
  ds_write_b128 v10, v[236:239] offset:11968
  ds_write_b128 v10, v[240:243] offset:13056
  ds_write_b128 v10, v[244:247] offset:14144
  ds_write_b128 v10, v[248:251] offset:15232
  ds_write_b128 v10, v[252:255] offset:16320
  s_waitcnt lgkmcnt(0)
  s_barrier
  ds_read_b128 v[32:35], v11 offset:0
  ds_read_b128 v[36:39], v11 offset:512
  ds_read_b128 v[40:43], v11 offset:17408
  ds_read_b128 v[44:47], v11 offset:17920
  ds_read_b128 v[48:51], v11 offset:34816
  ds_read_b128 v[52:55], v11 offset:35328
  ds_read_b128 v[56:59], v11 offset:52224
  ds_read_b128 v[60:63], v11 offset:52736
  ds_read_b128 v[64:67], v11 offset:128
  ds_read_b128 v[68:71], v11 offset:640
  ds_read_b128 v[72:75], v11 offset:17536
  ds_read_b128 v[76:79], v11 offset:18048
  ds_read_b128 v[80:83], v11 offset:34944
  ds_read_b128 v[84:87], v11 offset:35456
  ds_read_b128 v[88:91], v11 offset:52352
  ds_read_b128 v[92:95], v11 offset:52864
  s_waitcnt lgkmcnt(8)
  v_add_f32 v32, v32, v40
  v_add_f32 v33, v33, v41
  v_add_f32 v48, v48, v56
  v_add_f32 v49, v49, v57
  v_add_f32 v34, v34, v42
  v_add_f32 v35, v35, v43
  v_add_f32 v50, v50, v58
  v_add_f32 v51, v51, v59
  v_add_f32 v36, v36, v44
  v_add_f32 v37, v37, v45
  v_add_f32 v52, v52, v60
  v_add_f32 v53, v53, v61
  v_add_f32 v38, v38, v46
  v_add_f32 v39, v39, v47
  v_add_f32 v54, v54, v62
  v_add_f32 v55, v55, v63
  v_add_f32 v112, v32, v48
  v_add_f32 v113, v33, v49
  v_add_f32 v114, v34, v50
  v_add_f32 v115, v35, v51
  v_add_f32 v116, v36, v52
  v_add_f32 v117, v37, v53
  v_add_f32 v118, v38, v54
  v_add_f32 v119, v39, v55
  s_waitcnt lgkmcnt(0)
  v_add_f32 v64, v64, v72
  v_add_f32 v65, v65, v73
  v_add_f32 v80, v80, v88
  v_add_f32 v81, v81, v89
  v_add_f32 v66, v66, v74
  v_add_f32 v67, v67, v75
  v_add_f32 v82, v82, v90
  v_add_f32 v83, v83, v91
  v_add_f32 v68, v68, v76
  v_add_f32 v69, v69, v77
  v_add_f32 v84, v84, v92
  v_add_f32 v85, v85, v93
  v_add_f32 v70, v70, v78
  v_add_f32 v71, v71, v79
  v_add_f32 v86, v86, v94
  v_add_f32 v87, v87, v95
  v_add_f32 v120, v64, v80
  v_add_f32 v121, v65, v81
  v_add_f32 v122, v66, v82
  v_add_f32 v123, v67, v83
  v_add_f32 v124, v68, v84
  v_add_f32 v125, v69, v85
  v_add_f32 v126, v70, v86
  v_add_f32 v127, v71, v87
  s_mov_b32 s48, 0xbfb8aa3b
  s_mov_b32 s49, s48
  s_mov_b32 s50, 1.0
  s_mov_b32 s51, 1.0
  v_mul_f32 v192, s48, v112
  v_mul_f32 v193, s49, v113
  v_mul_f32 v194, s48, v114
  v_mul_f32 v195, s49, v115
  v_mul_f32 v196, s48, v116
  v_mul_f32 v197, s49, v117
  v_mul_f32 v198, s48, v118
  v_mul_f32 v199, s49, v119
  v_mul_f32 v200, s48, v120
  v_mul_f32 v201, s49, v121
  v_mul_f32 v202, s48, v122
  v_mul_f32 v203, s49, v123
  v_mul_f32 v204, s48, v124
  v_mul_f32 v205, s49, v125
  v_mul_f32 v206, s48, v126
  v_mul_f32 v207, s49, v127
  v_exp_f32 v192, v192
  v_exp_f32 v193, v193
  v_exp_f32 v194, v194
  v_exp_f32 v195, v195
  v_exp_f32 v196, v196
  v_exp_f32 v197, v197
  v_exp_f32 v198, v198
  v_exp_f32 v199, v199
  v_exp_f32 v200, v200
  v_exp_f32 v201, v201
  v_exp_f32 v202, v202
  v_exp_f32 v203, v203
  v_exp_f32 v204, v204
  v_exp_f32 v205, v205
  v_exp_f32 v206, v206
  v_exp_f32 v207, v207
  s_nop 0
  v_add_f32 v192, s50, v192
  v_add_f32 v193, s51, v193
  v_add_f32 v194, s50, v194
  v_add_f32 v195, s51, v195
  v_add_f32 v196, s50, v196
  v_add_f32 v197, s51, v197
  v_add_f32 v198, s50, v198
  v_add_f32 v199, s51, v199
  v_add_f32 v200, s50, v200
  v_add_f32 v201, s51, v201
  v_add_f32 v202, s50, v202
  v_add_f32 v203, s51, v203
  v_add_f32 v204, s50, v204
  v_add_f32 v205, s51, v205
  v_add_f32 v206, s50, v206
  v_add_f32 v207, s51, v207
  v_rcp_f32 v192, v192
  v_rcp_f32 v193, v193
  v_rcp_f32 v194, v194
  v_rcp_f32 v195, v195
  v_rcp_f32 v196, v196
  v_rcp_f32 v197, v197
  v_rcp_f32 v198, v198
  v_rcp_f32 v199, v199
  v_rcp_f32 v200, v200
  v_rcp_f32 v201, v201
  v_rcp_f32 v202, v202
  v_rcp_f32 v203, v203
  v_rcp_f32 v204, v204
  v_rcp_f32 v205, v205
  v_rcp_f32 v206, v206
  v_rcp_f32 v207, v207
  s_nop 0
  v_mul_f32 v112, v112, v192
  v_mul_f32 v113, v113, v193
  v_mul_f32 v114, v114, v194
  v_mul_f32 v115, v115, v195
  v_mul_f32 v116, v116, v196
  v_mul_f32 v117, v117, v197
  v_mul_f32 v118, v118, v198
  v_mul_f32 v119, v119, v199
  v_mul_f32 v120, v120, v200
  v_mul_f32 v121, v121, v201
  v_mul_f32 v122, v122, v202
  v_mul_f32 v123, v123, v203
  v_mul_f32 v124, v124, v204
  v_mul_f32 v125, v125, v205
  v_mul_f32 v126, v126, v206
  v_mul_f32 v127, v127, v207
  s_mov_b32 s48, 0xffff0000
  v_lshlrev_b32 v16, 16, v96
  v_and_b32 v17, s48, v96
  v_lshlrev_b32 v18, 16, v97
  v_and_b32 v19, s48, v97
  v_lshlrev_b32 v20, 16, v98
  v_and_b32 v21, s48, v98
  v_lshlrev_b32 v22, 16, v99
  v_and_b32 v23, s48, v99
  v_lshlrev_b32 v24, 16, v100
  v_and_b32 v25, s48, v100
  v_lshlrev_b32 v26, 16, v101
  v_and_b32 v27, s48, v101
  v_lshlrev_b32 v28, 16, v102
  v_and_b32 v29, s48, v102
  v_lshlrev_b32 v30, 16, v103
  v_and_b32 v31, s48, v103
  s_waitcnt lgkmcnt(0)
  s_setprio 0
  v_and_b32 v12, 31, v2
  v_lshlrev_b32 v12, 7, v12
  s_cmp_lg_u32 s16, 0
  s_cbranch_scc1 .Lrecurr_np39
  s_mov_b32 s60, 0x40000
.Lrecurr_poll40:
  buffer_load_dwordx2 v[4:5], v12, s[28:31], s53 offen sc1
  s_waitcnt vmcnt(0)
  v_cmp_eq_u64 vcc, s[58:59], v[4:5]
  s_cmp_eq_u64 vcc, -1
  s_cbranch_scc1 .Lrecurr_polld41
  s_sleep 2
  s_sub_u32 s60, s60, 1
  s_cmp_lg_u32 s60, 0
  s_cbranch_scc1 .Lrecurr_poll40
.Lrecurr_polld41:
.Lrecurr_np39:
  s_waitcnt vmcnt(0)
  s_barrier
  s_setprio 3
  buffer_load_dwordx4 v[32:35], v3, s[28:31], s23 offen sc1
  buffer_load_dwordx4 v[36:39], v107, s[28:31], s23 offen sc1
  s_add_u32 s23, s23, 0x400
  buffer_load_dwordx4 v[40:43], v3, s[28:31], s23 offen sc1
  buffer_load_dwordx4 v[44:47], v107, s[28:31], s23 offen sc1
  s_add_u32 s23, s23, 0x400
  buffer_load_dwordx4 v[48:51], v3, s[28:31], s23 offen sc1
  buffer_load_dwordx4 v[52:55], v107, s[28:31], s23 offen sc1
  s_add_u32 s23, s23, 0x400
  buffer_load_dwordx4 v[56:59], v3, s[28:31], s23 offen sc1
  buffer_load_dwordx4 v[60:63], v107, s[28:31], s23 offen sc1
  s_add_u32 s23, s23, 0x400
  buffer_load_dwordx4 v[64:67], v3, s[28:31], s23 offen sc1
  buffer_load_dwordx4 v[68:71], v107, s[28:31], s23 offen sc1
  s_add_u32 s23, s23, 0x400
  buffer_load_dwordx4 v[72:75], v3, s[28:31], s23 offen sc1
  buffer_load_dwordx4 v[76:79], v107, s[28:31], s23 offen sc1
  s_add_u32 s23, s23, 0x400
  buffer_load_dwordx4 v[80:83], v3, s[28:31], s23 offen sc1
  buffer_load_dwordx4 v[84:87], v107, s[28:31], s23 offen sc1
  s_add_u32 s23, s23, 0x400
  buffer_load_dwordx4 v[88:91], v3, s[28:31], s23 offen sc1
  buffer_load_dwordx4 v[92:95], v107, s[28:31], s23 offen sc1
  s_add_u32 s23, s23, 0x400
  s_waitcnt vmcnt(14)
  v_mfma_f32_32x32x16_bf16 v[192:207], v[128:131], v[32:35], 0
  v_mfma_f32_32x32x16_bf16 v[208:223], v[132:135], v[32:35], 0
  v_mfma_f32_32x32x16_bf16 v[224:239], v[128:131], v[36:39], 0
  v_mfma_f32_32x32x16_bf16 v[240:255], v[132:135], v[36:39], 0
  s_waitcnt vmcnt(12)
  v_mfma_f32_32x32x16_bf16 v[192:207], v[136:139], v[40:43], v[192:207]
  v_mfma_f32_32x32x16_bf16 v[208:223], v[140:143], v[40:43], v[208:223]
  v_mfma_f32_32x32x16_bf16 v[224:239], v[136:139], v[44:47], v[224:239]
  v_mfma_f32_32x32x16_bf16 v[240:255], v[140:143], v[44:47], v[240:255]
  s_waitcnt vmcnt(10)
  v_mfma_f32_32x32x16_bf16 v[192:207], v[144:147], v[48:51], v[192:207]
  v_mfma_f32_32x32x16_bf16 v[208:223], v[148:151], v[48:51], v[208:223]
  v_mfma_f32_32x32x16_bf16 v[224:239], v[144:147], v[52:55], v[224:239]
  v_mfma_f32_32x32x16_bf16 v[240:255], v[148:151], v[52:55], v[240:255]
  s_waitcnt vmcnt(8)
  v_mfma_f32_32x32x16_bf16 v[192:207], v[152:155], v[56:59], v[192:207]
  v_mfma_f32_32x32x16_bf16 v[208:223], v[156:159], v[56:59], v[208:223]
  v_mfma_f32_32x32x16_bf16 v[224:239], v[152:155], v[60:63], v[224:239]
  v_mfma_f32_32x32x16_bf16 v[240:255], v[156:159], v[60:63], v[240:255]
  s_waitcnt vmcnt(6)
  v_mfma_f32_32x32x16_bf16 v[192:207], v[160:163], v[64:67], v[192:207]
  v_mfma_f32_32x32x16_bf16 v[208:223], v[164:167], v[64:67], v[208:223]
  v_mfma_f32_32x32x16_bf16 v[224:239], v[160:163], v[68:71], v[224:239]
  v_mfma_f32_32x32x16_bf16 v[240:255], v[164:167], v[68:71], v[240:255]
  s_waitcnt vmcnt(4)
  v_mfma_f32_32x32x16_bf16 v[192:207], v[168:171], v[72:75], v[192:207]
  v_mfma_f32_32x32x16_bf16 v[208:223], v[172:175], v[72:75], v[208:223]
  v_mfma_f32_32x32x16_bf16 v[224:239], v[168:171], v[76:79], v[224:239]
  v_mfma_f32_32x32x16_bf16 v[240:255], v[172:175], v[76:79], v[240:255]
  s_waitcnt vmcnt(2)
  v_mfma_f32_32x32x16_bf16 v[192:207], v[176:179], v[80:83], v[192:207]
  v_mfma_f32_32x32x16_bf16 v[208:223], v[180:183], v[80:83], v[208:223]
  v_mfma_f32_32x32x16_bf16 v[224:239], v[176:179], v[84:87], v[224:239]
  v_mfma_f32_32x32x16_bf16 v[240:255], v[180:183], v[84:87], v[240:255]
  s_waitcnt vmcnt(0)
  v_mfma_f32_32x32x16_bf16 v[192:207], v[184:187], v[88:91], v[192:207]
  v_mfma_f32_32x32x16_bf16 v[208:223], v[188:191], v[88:91], v[208:223]
  v_mfma_f32_32x32x16_bf16 v[224:239], v[184:187], v[92:95], v[224:239]
  v_mfma_f32_32x32x16_bf16 v[240:255], v[188:191], v[92:95], v[240:255]
  s_nop 8
  ds_write_b128 v10, v[192:195] offset:0
  ds_write_b128 v10, v[196:199] offset:1088
  ds_write_b128 v10, v[200:203] offset:2176
  ds_write_b128 v10, v[204:207] offset:3264
  ds_write_b128 v10, v[208:211] offset:4352
  ds_write_b128 v10, v[212:215] offset:5440
  ds_write_b128 v10, v[216:219] offset:6528
  ds_write_b128 v10, v[220:223] offset:7616
  ds_write_b128 v10, v[224:227] offset:8704
  ds_write_b128 v10, v[228:231] offset:9792
  ds_write_b128 v10, v[232:235] offset:10880
  ds_write_b128 v10, v[236:239] offset:11968
  ds_write_b128 v10, v[240:243] offset:13056
  ds_write_b128 v10, v[244:247] offset:14144
  ds_write_b128 v10, v[248:251] offset:15232
  ds_write_b128 v10, v[252:255] offset:16320
  s_waitcnt lgkmcnt(0)
  s_barrier
  ds_read_b128 v[32:35], v11 offset:0
  ds_read_b128 v[36:39], v11 offset:512
  ds_read_b128 v[40:43], v11 offset:17408
  ds_read_b128 v[44:47], v11 offset:17920
  ds_read_b128 v[48:51], v11 offset:34816
  ds_read_b128 v[52:55], v11 offset:35328
  ds_read_b128 v[56:59], v11 offset:52224
  ds_read_b128 v[60:63], v11 offset:52736
  ds_read_b128 v[64:67], v11 offset:128
  ds_read_b128 v[68:71], v11 offset:640
  ds_read_b128 v[72:75], v11 offset:17536
  ds_read_b128 v[76:79], v11 offset:18048
  ds_read_b128 v[80:83], v11 offset:34944
  ds_read_b128 v[84:87], v11 offset:35456
  ds_read_b128 v[88:91], v11 offset:52352
  ds_read_b128 v[92:95], v11 offset:52864
  s_waitcnt lgkmcnt(8)
  v_add_f32 v32, v32, v40
  v_add_f32 v33, v33, v41
  v_add_f32 v48, v48, v56
  v_add_f32 v49, v49, v57
  v_add_f32 v34, v34, v42
  v_add_f32 v35, v35, v43
  v_add_f32 v50, v50, v58
  v_add_f32 v51, v51, v59
  v_add_f32 v36, v36, v44
  v_add_f32 v37, v37, v45
  v_add_f32 v52, v52, v60
  v_add_f32 v53, v53, v61
  v_add_f32 v38, v38, v46
  v_add_f32 v39, v39, v47
  v_add_f32 v54, v54, v62
  v_add_f32 v55, v55, v63
  v_add_f32 v192, v32, v48
  v_add_f32 v193, v33, v49
  v_add_f32 v194, v34, v50
  v_add_f32 v195, v35, v51
  v_add_f32 v196, v36, v52
  v_add_f32 v197, v37, v53
  v_add_f32 v198, v38, v54
  v_add_f32 v199, v39, v55
  s_waitcnt lgkmcnt(0)
  v_add_f32 v64, v64, v72
  v_add_f32 v65, v65, v73
  v_add_f32 v80, v80, v88
  v_add_f32 v81, v81, v89
  v_add_f32 v66, v66, v74
  v_add_f32 v67, v67, v75
  v_add_f32 v82, v82, v90
  v_add_f32 v83, v83, v91
  v_add_f32 v68, v68, v76
  v_add_f32 v69, v69, v77
  v_add_f32 v84, v84, v92
  v_add_f32 v85, v85, v93
  v_add_f32 v70, v70, v78
  v_add_f32 v71, v71, v79
  v_add_f32 v86, v86, v94
  v_add_f32 v87, v87, v95
  v_add_f32 v200, v64, v80
  v_add_f32 v201, v65, v81
  v_add_f32 v202, v66, v82
  v_add_f32 v203, v67, v83
  v_add_f32 v204, v68, v84
  v_add_f32 v205, v69, v85
  v_add_f32 v206, v70, v86
  v_add_f32 v207, v71, v87
  v_fma_f32 v16, v192, v112, v16
  v_fma_f32 v17, v193, v113, v17
  v_fma_f32 v18, v194, v114, v18
  v_fma_f32 v19, v195, v115, v19
  v_fma_f32 v20, v196, v116, v20
  v_fma_f32 v21, v197, v117, v21
  v_fma_f32 v22, v198, v118, v22
  v_fma_f32 v23, v199, v119, v23
  v_cvt_pk_bf16_f32 v96, v16, v17
  v_cvt_pk_bf16_f32 v97, v18, v19
  v_cvt_pk_bf16_f32 v98, v20, v21
  v_cvt_pk_bf16_f32 v99, v22, v23
  buffer_store_dwordx4 v[96:99], v14, s[40:43], s46 offen
  v_fma_f32 v24, v200, v120, v24
  v_fma_f32 v25, v201, v121, v25
  v_fma_f32 v26, v202, v122, v26
  v_fma_f32 v27, v203, v123, v27
  v_fma_f32 v28, v204, v124, v28
  v_fma_f32 v29, v205, v125, v29
  v_fma_f32 v30, v206, v126, v30
  v_fma_f32 v31, v207, v127, v31
  v_cvt_pk_bf16_f32 v100, v24, v25
  v_cvt_pk_bf16_f32 v101, v26, v27
  v_cvt_pk_bf16_f32 v102, v28, v29
  v_cvt_pk_bf16_f32 v103, v30, v31
  buffer_store_dwordx4 v[100:103], v14, s[40:43], s47 offen
  s_endpgm
.Lrecurr_end1:
  s_endpgm
.Lcode_end:
.section .rodata,"a"
.p2align 6
.amdhsa_kernel recurrent_scan__grouped_kv_mqa__geglu_ffn__prompt_kernel
  .amdhsa_next_free_vgpr 256
  .amdhsa_next_free_sgpr 64
  .amdhsa_accum_offset 256
  .amdhsa_group_segment_fixed_size 0
  .amdhsa_kernarg_size 96
  .amdhsa_user_sgpr_count 2
  .amdhsa_user_sgpr_kernarg_segment_ptr 1
  .amdhsa_system_sgpr_workgroup_id_x 1
.end_amdhsa_kernel
```
